```python
import torch

def _softmax(x, axis=-1):
    return torch.softmax(x, dim=axis)
def _gelu(x):
    return torch.nn.functional.gelu(x, approximate="tanh")
def _silu(x):
    return torch.nn.functional.silu(x)
def _sigmoid(x):
    return torch.sigmoid(x)
def _layernorm(x, axis=-1, eps=1e-5):
    m = x.mean(dim=axis, keepdim=True)
    v = x.var(dim=axis, keepdim=True, unbiased=False)
    return (x - m) / torch.sqrt(v + eps)
def _scatter_add(tgt, idx, src, axis=0):
    return tgt.clone().index_add_(axis, idx, src)
def _segment_sum(src, seg, n):
    out = torch.zeros((n,) + src.shape[1:], dtype=src.dtype)
    return out.index_add_(0, seg, src)
def _pad(x, pw):
    flat = tuple(v for pair in reversed(pw) for v in pair)
    return torch.nn.functional.pad(x, flat)

kernel_name = 'recurrent_scan__ssm_conv_s4__swiglu_ffn__prompt'

def setup_inputs():

    _w = (lambda a: (lambda t: t.to(torch.bfloat16) if t.is_floating_point() else t)(torch.as_tensor(a)))
    def _A_setup():
        B, L, D, N = 1, 2048, 512, 128
        A_re = -(lambda _x: torch.exp(torch.as_tensor(_x)))((lambda *s: torch.randn(*s, dtype=torch.bfloat16) * 3.2)(D, N))
        A_im = torch.pi * (lambda *s: torch.randn(*s, dtype=torch.bfloat16) * 0.05)(D, N)
        B_re = (lambda *s: torch.randn(*s, dtype=torch.bfloat16) * 0.1)(D, N)
        B_im = (lambda *s: torch.randn(*s, dtype=torch.bfloat16) * 0.1)(D, N)
        C_re = (lambda *s: torch.randn(*s, dtype=torch.bfloat16) * 0.1)(D, N)
        C_im = (lambda *s: torch.randn(*s, dtype=torch.bfloat16) * 0.1)(D, N)
        log_dt = (lambda *s: torch.randn(*s, dtype=torch.bfloat16) * 0.05)(D) * 0.5 - 4.0
        Dskip = (lambda *s: torch.randn(*s, dtype=torch.bfloat16) * 0.05)(D)
        return {
            "u": _w((lambda *s: torch.randn(*s, dtype=torch.bfloat16) * 0.05)(B, L, D)),
            "A_re": _w(A_re),
            "A_im": _w(A_im),
            "B_re": _w(B_re),
            "B_im": _w(B_im),
            "C_re": _w(C_re),
            "C_im": _w(C_im),
            "log_dt": _w(log_dt),
            "Dskip": _w(Dskip),
        }
    _A_in = _A_setup()

    def _B_setup():
        B, S, D, F = 1, 2048, 512, 1792
        return {
            "x": _w((lambda *s: torch.randn(*s, dtype=torch.bfloat16) * 0.05)(B, S, D)),
            "w_gate": _w((lambda *s: torch.randn(*s, dtype=torch.bfloat16) * 0.05)(D, F)),
            "w_up": _w((lambda *s: torch.randn(*s, dtype=torch.bfloat16) * 0.05)(D, F)),
            "w_down": _w((lambda *s: torch.randn(*s, dtype=torch.bfloat16) * 0.05)(F, D)),
        }
    _B_in = _B_setup()

    return {
        "A_u": _A_in["u"],
        "A_A_re": _A_in["A_re"],
        "A_A_im": _A_in["A_im"],
        "A_B_re": _A_in["B_re"],
        "A_B_im": _A_in["B_im"],
        "A_C_re": _A_in["C_re"],
        "A_C_im": _A_in["C_im"],
        "A_log_dt": _A_in["log_dt"],
        "A_Dskip": _A_in["Dskip"],
        "B_x": _B_in["x"],
        "B_w_gate": _B_in["w_gate"],
        "B_w_up": _B_in["w_up"],
        "B_w_down": _B_in["w_down"],
    }

def reference(A_u, A_A_re, A_A_im, A_B_re, A_B_im, A_C_re, A_C_im, A_log_dt, A_Dskip, B_x, B_w_gate, B_w_up, B_w_down):
    def _A_ref(u, A_re, A_im, B_re, B_im, C_re, C_im, log_dt, Dskip):
        Bsz, L, D = u.shape
        dt = torch.exp(log_dt)[:, None]
        A = A_re + 1j * A_im
        Bc = B_re + 1j * B_im
        Cc = C_re + 1j * C_im
        logdA = dt * A
        dB = dt * Bc
        l = (lambda x, dt: x.to(dt))(torch.arange(L), A_re.dtype)
        P = torch.exp(logdA[:, :, None] * l[None, None, :])
        K = torch.einsum("dn,dnl,dn->dl", Cc, P, dB).real
        L2 = 2 * L
        Kp = _pad(K, ((0, 0), (0, L)))
        up = (lambda x, *d: x.permute(*d))(u, 0, 2, 1)
        up = _pad(up, ((0, 0), (0, 0), (0, L)))
        Kf = (lambda x, axes=(-2,-1): torch.fft.rfft2(x.float(), dim=axes))(Kp[:, None, :], axes=(-2, -1))
        Uf = (lambda x, axes=(-2,-1): torch.fft.rfft2(x.float(), dim=axes))(up[:, :, None, :], axes=(-2, -1))
        Yf = Uf * Kf[None, :, :, :]
        y = (lambda x, s, axes=(-2,-1): torch.fft.irfft2(x, s=s, dim=axes).to(torch.bfloat16))(Yf, (1, L2), axes=(-2, -1))[:, :, 0, :L]
        y = (lambda x, *d: x.permute(*d))(y, 0, 2, 1) + u * Dskip[None, None, :]
        return y

    def _B_ref(x, w_gate, w_up, w_down):
        g = _silu(x @ w_gate)
        u = x @ w_up
        return (g * u) @ w_down

    x = A_u
    xn = _layernorm(x, axis=-1)
    s = _A_ref(xn, A_A_re, A_A_im, A_B_re, A_B_im, A_C_re, A_C_im, A_log_dt, A_Dskip)
    g = _silu(_B_ref(xn, B_w_gate, B_w_up, B_w_down))
    return x + s * g
```

```asm
; @launch grid=(256,1,1) block=(512,1,1) lds=150208
.amdgcn_target "amdgcn-amd-amdhsa--gfx950"
.text
.globl recurrent_scan__ssm_conv_s4__swiglu_ffn__prompt_kernel
.p2align 8
.type recurrent_scan__ssm_conv_s4__swiglu_ffn__prompt_kernel,@function
recurrent_scan__ssm_conv_s4__swiglu_ffn__prompt_kernel:
    s_cmp_ge_u32 s2, 256
    s_cbranch_scc1 MK_END
    s_getpc_b64 s[94:95]
MK_PC:
    s_load_dwordx2 s[4:5], s[0:1], 0
    s_load_dwordx4 s[28:31], s[0:1], 80
    s_load_dwordx2 s[6:7], s[0:1], 96
    s_load_dwordx4 s[32:35], s[0:1], 112
    s_load_dwordx16 s[40:55], s[0:1], 0
    s_load_dwordx2 s[56:57], s[0:1], 64
    s_load_dwordx2 s[96:97], s[0:1], 104
    v_lshrrev_b32 v1, 6, v0
    s_nop 0
    v_readfirstlane_b32 s36, v1
    v_and_b32 v1, 63, v0
    s_and_b32 s37, s2, 7
    s_lshr_b32 s38, s2, 3
    s_lshl_b32 s92, s38, 3
    s_add_u32 s92, s92, s36
    s_lshl_b32 s92, s92, 10
    s_cmp_ge_u32 s92, MK_CODE_END-MK_PC
    s_cbranch_scc1 MK_NI_1
    s_min_u32 s92, s92, MK_CODE_END-MK_PC-1024
    v_lshlrev_b32 v2, 4, v1
    v_add_u32 v2, s92, v2
    global_load_dwordx4 v[240:243], v2, s[94:95]
MK_NI_1:
    s_getreg_b32 s90, hwreg(HW_REG_XCC_ID)
    s_and_b32 s90, s90, 15
    s_add_u32 s90, s90, 1
    v_and_b32 v2, 31, v1
    v_lshlrev_b32 v2, 2, v2
    v_add_u32 v2, 150080, v2
    v_mov_b32 v3, 0
    ds_write_b32 v2, v3
    s_waitcnt lgkmcnt(0)
    s_barrier
    s_mov_b32 s8, s4
    s_mov_b32 s9, s5
    s_mov_b32 s10, 0x200000
    s_mov_b32 s11, 0x00020000
    s_cmp_lt_u32 s36, 4
    s_cbranch_scc1 MK_NP_2
    s_bfe_u32 s58, s36, 0x10001
    s_lshl_b32 s59, s2, 1
    s_add_u32 s58, s58, s59
    s_lshl_b32 s58, s58, 8
    s_and_b32 s59, s36, 1
    s_lshl_b32 s59, s59, 7
    s_add_u32 s58, s58, s59
    v_lshl_add_u32 v2, v1, 1, s58
    global_load_ushort v246, v2, s[42:43]
    global_load_ushort v247, v2, s[44:45]
    global_load_ushort v248, v2, s[46:47]
    global_load_ushort v249, v2, s[48:49]
    global_load_ushort v250, v2, s[50:51]
    global_load_ushort v251, v2, s[52:53]
    s_lshl_b32 s58, s2, 2
    s_load_dword s100, s[54:55], s58
    s_load_dword s101, s[56:57], s58
MK_NP_2:
    s_lshl_b32 s53, s37, 5
    s_add_u32 s53, s53, s38
    s_mov_b32 s12, s28
    s_mov_b32 s13, s29
    s_mov_b32 s14, 0x1c0000
    s_mov_b32 s15, 0x00020000
    s_mov_b32 s16, s30
    s_mov_b32 s17, s31
    s_mov_b32 s18, 0x1c0000
    s_mov_b32 s19, 0x00020000
    s_mov_b32 s20, s34
    s_mov_b32 s21, s35
    s_mov_b32 s22, 0xe00000
    s_mov_b32 s23, 0x00020000
    s_cmp_ge_u32 s38, 28
    s_cbranch_scc1 MK_AUX
    s_mul_i32 s41, s38, 37
    s_lshr_b32 s41, s41, 8
    s_mul_i32 s42, s41, 7
    s_sub_u32 s42, s38, s42
    s_lshr_b32 s39, s37, 2
    s_lshl_b32 s39, s39, 2
    s_add_u32 s39, s39, s41
    s_and_b32 s40, s37, 3
    s_mul_i32 s40, s40, 7
    s_add_u32 s40, s40, s42
    v_lshrrev_b32 v16, 3, v1
    v_lshrrev_b32 v17, 4, v1
    v_and_b32 v18, 7, v1
    v_xor_b32 v19, v18, v17
    v_lshlrev_b32 v19, 4, v19
    v_lshl_add_u32 v2, v16, 10, v19
    v_xor_b32 v3, 64, v2
    v_mul_u32_u24 v4, 3584, v16
    v_and_b32 v19, 1, v17
    v_lshlrev_b32 v19, 2, v19
    v_xor_b32 v19, v19, v18
    v_lshl_add_u32 v4, v19, 4, v4
    s_cmp_ge_u32 s36, 4
    s_cbranch_scc1 A_LOAD
    s_lshl_b32 s43, s39, 18
    s_lshl_b32 s41, s36, 16
    s_add_u32 s43, s43, s41
    s_mul_i32 s42, s36, 57344
    s_lshl_b32 s41, s40, 7
    s_add_u32 s42, s42, s41
    s_lshl_b32 s44, s36, 13
    s_lshl_b32 s45, s36, 11
    s_add_u32 s45, s45, 98304
    s_add_u32 s41, s39, 0
    s_and_b32 s41, s41, 7
    s_lshl_b32 s55, s41, 7
    s_add_u32 s55, s55, s43
    s_mul_i32 s41, s41, 229376
    s_add_u32 s41, s41, s42
    s_add_u32 s49, s41, 28672
    s_add_u32 m0, s45, 0
    s_nop 0
    buffer_load_dwordx4 v4, s[12:15], s41 offen lds
    s_add_u32 m0, s45, 1024
    s_nop 0
    buffer_load_dwordx4 v4, s[12:15], s49 offen lds
    s_add_u32 m0, s45, 8192
    s_nop 0
    buffer_load_dwordx4 v4, s[16:19], s41 offen lds
    s_add_u32 m0, s45, 9216
    s_nop 0
    buffer_load_dwordx4 v4, s[16:19], s49 offen lds
    s_add_u32 m0, s44, 0
    s_add_u32 s46, s55, 0
    buffer_load_dwordx4 v2, s[8:11], s46 offen lds
    s_add_u32 m0, s44, 1024
    s_add_u32 s46, s55, 8192
    buffer_load_dwordx4 v3, s[8:11], s46 offen lds
    s_add_u32 m0, s44, 2048
    s_add_u32 s46, s55, 16384
    buffer_load_dwordx4 v2, s[8:11], s46 offen lds
    s_add_u32 m0, s44, 3072
    s_add_u32 s46, s55, 24576
    buffer_load_dwordx4 v3, s[8:11], s46 offen lds
    s_add_u32 m0, s44, 4096
    s_add_u32 s46, s55, 32768
    buffer_load_dwordx4 v2, s[8:11], s46 offen lds
    s_add_u32 m0, s44, 5120
    s_add_u32 s46, s55, 40960
    buffer_load_dwordx4 v3, s[8:11], s46 offen lds
    s_add_u32 m0, s44, 6144
    s_add_u32 s46, s55, 49152
    buffer_load_dwordx4 v2, s[8:11], s46 offen lds
    s_add_u32 m0, s44, 7168
    s_add_u32 s46, s55, 57344
    buffer_load_dwordx4 v3, s[8:11], s46 offen lds
    v_mov_b32 v56, 150164
    v_mov_b32 v57, 1
    s_mov_b64 exec, 1
    ds_add_u32 v56, v57
    s_mov_b64 exec, -1
    v_lshlrev_b32 v245, 4, v1
    s_mov_b32 s24, s32
    s_mov_b32 s25, s33
    s_mov_b32 s26, 0x100
    s_mov_b32 s27, 0x00020000
    s_setprio 2
    s_lshr_b32 s47, s36, 1
    s_and_b32 s48, s36, 1
    v_and_b32 v16, 31, v1
    v_lshlrev_b32 v16, 7, v16
    s_lshl_b32 s41, s47, 14
    v_add_u32 v16, s41, v16
    v_lshrrev_b32 v17, 5, v1
    v_bfe_u32 v18, v1, 1, 3
    v_add_u32 v19, 0, v17
    v_xor_b32 v19, v19, v18
    v_lshl_add_u32 v6, v19, 4, v16
    v_add_u32 v10, 65536, v6
    v_add_u32 v19, 2, v17
    v_xor_b32 v19, v19, v18
    v_lshl_add_u32 v7, v19, 4, v16
    v_add_u32 v11, 65536, v7
    v_add_u32 v19, 4, v17
    v_xor_b32 v19, v19, v18
    v_lshl_add_u32 v8, v19, 4, v16
    v_add_u32 v12, 65536, v8
    v_add_u32 v19, 6, v17
    v_xor_b32 v19, v19, v18
    v_lshl_add_u32 v9, v19, 4, v16
    v_add_u32 v13, 65536, v9
    v_bfe_u32 v18, v1, 2, 2
    v_lshl_add_u32 v19, v17, 3, v18
    v_lshlrev_b32 v19, 7, v19
    v_lshrrev_b32 v20, 1, v18
    v_xor_b32 v20, s48, v20
    v_lshlrev_b32 v20, 2, v20
    v_bfe_u32 v21, v1, 4, 1
    v_lshl_add_u32 v20, v21, 1, v20
    v_bfe_u32 v21, v1, 1, 1
    v_add_u32 v20, v20, v21
    v_lshl_add_u32 v19, v20, 4, v19
    v_and_b32 v21, 1, v1
    v_lshl_add_u32 v19, v21, 3, v19
    v_add_u32 v5, 98304, v19
    v_mov_b32 v48, 0x3f803f80
    v_mov_b32 v49, 0x3f803f80
    v_mov_b32 v50, 0x3f803f80
    v_mov_b32 v51, 0x3f803f80
    s_waitcnt vmcnt(0)
    v_mov_b32 v56, 150160
    v_mov_b32 v57, 1
    s_mov_b64 exec, 1
    ds_add_u32 v56, v57
    s_mov_b64 exec, -1
A_C0:
    ds_read_b32 v57, v56
    s_waitcnt lgkmcnt(0)
    v_readfirstlane_b32 s41, v57
    s_nop 0
    s_cmp_lt_u32 s41, 4
    s_cbranch_scc1 A_C0
    ds_read_b64_tr_b16 v[192:193], v5 offset:0
    ds_read_b64_tr_b16 v[194:195], v5 offset:512
    ds_read_b128 v[196:199], v6 offset:0
    ds_read_b128 v[200:203], v6 offset:4096
    ds_read_b128 v[204:207], v6 offset:8192
    ds_read_b128 v[208:211], v6 offset:12288
    ds_read_b64_tr_b16 v[212:213], v5 offset:8192
    ds_read_b64_tr_b16 v[214:215], v5 offset:8704
    s_waitcnt lgkmcnt(0)
    v_mfma_f32_32x32x16_bf16 v[64:79], v[192:195], v[196:199], 0
    ds_read_b64_tr_b16 v[216:217], v5 offset:2048
    ds_read_b64_tr_b16 v[218:219], v5 offset:2560
    v_mfma_f32_32x32x16_bf16 v[80:95], v[192:195], v[200:203], 0
    ds_read_b128 v[220:223], v7 offset:0
    ds_read_b128 v[224:227], v7 offset:4096
    v_mfma_f32_32x32x16_bf16 v[96:111], v[192:195], v[204:207], 0
    ds_read_b128 v[228:231], v7 offset:8192
    ds_read_b128 v[232:235], v7 offset:12288
    v_mfma_f32_32x32x16_bf16 v[112:127], v[192:195], v[208:211], 0
    ds_read_b64_tr_b16 v[236:237], v5 offset:10240
    ds_read_b64_tr_b16 v[238:239], v5 offset:10752
    v_mfma_f32_32x32x16_bf16 v[128:143], v[212:215], v[196:199], 0
    v_mfma_f32_32x32x16_bf16 v[144:159], v[212:215], v[200:203], 0
    v_mfma_f32_32x32x16_bf16 v[160:175], v[212:215], v[204:207], 0
    v_mfma_f32_32x32x16_bf16 v[176:191], v[212:215], v[208:211], 0
    s_cmp_lg_u32 s47, 0
    s_cbranch_scc1 A_CM_3
    v_mfma_f32_32x32x16_bf16 v[16:31], v[192:195], v[48:51], 0
    v_mfma_f32_32x32x16_bf16 v[32:47], v[212:215], v[48:51], 0
A_CM_3:
    s_waitcnt lgkmcnt(0)
    v_mfma_f32_32x32x16_bf16 v[64:79], v[216:219], v[220:223], v[64:79]
    ds_read_b64_tr_b16 v[192:193], v5 offset:4096
    ds_read_b64_tr_b16 v[194:195], v5 offset:4608
    v_mfma_f32_32x32x16_bf16 v[80:95], v[216:219], v[224:227], v[80:95]
    ds_read_b128 v[196:199], v8 offset:0
    ds_read_b128 v[200:203], v8 offset:4096
    v_mfma_f32_32x32x16_bf16 v[96:111], v[216:219], v[228:231], v[96:111]
    ds_read_b128 v[204:207], v8 offset:8192
    ds_read_b128 v[208:211], v8 offset:12288
    v_mfma_f32_32x32x16_bf16 v[112:127], v[216:219], v[232:235], v[112:127]
    ds_read_b64_tr_b16 v[212:213], v5 offset:12288
    ds_read_b64_tr_b16 v[214:215], v5 offset:12800
    v_mfma_f32_32x32x16_bf16 v[128:143], v[236:239], v[220:223], v[128:143]
    v_mfma_f32_32x32x16_bf16 v[144:159], v[236:239], v[224:227], v[144:159]
    v_mfma_f32_32x32x16_bf16 v[160:175], v[236:239], v[228:231], v[160:175]
    v_mfma_f32_32x32x16_bf16 v[176:191], v[236:239], v[232:235], v[176:191]
    s_cmp_lg_u32 s47, 0
    s_cbranch_scc1 A_CM_4
    v_mfma_f32_32x32x16_bf16 v[16:31], v[216:219], v[48:51], v[16:31]
    v_mfma_f32_32x32x16_bf16 v[32:47], v[236:239], v[48:51], v[32:47]
A_CM_4:
    s_waitcnt lgkmcnt(0)
    v_mfma_f32_32x32x16_bf16 v[64:79], v[192:195], v[196:199], v[64:79]
    ds_read_b64_tr_b16 v[216:217], v5 offset:6144
    ds_read_b64_tr_b16 v[218:219], v5 offset:6656
    v_mfma_f32_32x32x16_bf16 v[80:95], v[192:195], v[200:203], v[80:95]
    ds_read_b128 v[220:223], v9 offset:0
    ds_read_b128 v[224:227], v9 offset:4096
    v_mfma_f32_32x32x16_bf16 v[96:111], v[192:195], v[204:207], v[96:111]
    ds_read_b128 v[228:231], v9 offset:8192
    ds_read_b128 v[232:235], v9 offset:12288
    v_mfma_f32_32x32x16_bf16 v[112:127], v[192:195], v[208:211], v[112:127]
    ds_read_b64_tr_b16 v[236:237], v5 offset:14336
    ds_read_b64_tr_b16 v[238:239], v5 offset:14848
    v_mfma_f32_32x32x16_bf16 v[128:143], v[212:215], v[196:199], v[128:143]
    v_mfma_f32_32x32x16_bf16 v[144:159], v[212:215], v[200:203], v[144:159]
    v_mfma_f32_32x32x16_bf16 v[160:175], v[212:215], v[204:207], v[160:175]
    v_mfma_f32_32x32x16_bf16 v[176:191], v[212:215], v[208:211], v[176:191]
    s_cmp_lg_u32 s47, 1
    s_cbranch_scc1 A_CM_5
    v_mfma_f32_32x32x16_bf16 v[16:31], v[192:195], v[48:51], 0
    v_mfma_f32_32x32x16_bf16 v[32:47], v[212:215], v[48:51], 0
A_CM_5:
    s_waitcnt lgkmcnt(0)
    v_mfma_f32_32x32x16_bf16 v[64:79], v[216:219], v[220:223], v[64:79]
    s_barrier
    s_bfe_u32 s58, s36, 0x10001
    s_lshl_b32 s59, s2, 1
    s_add_u32 s58, s58, s59
    s_lshl_b32 s58, s58, 12
    s_and_b32 s59, s36, 1
    s_lshl_b32 s59, s59, 11
    s_add_u32 s58, s58, s59
    s_add_u32 s58, s58, 11272192
    v_mov_b32 v240, -1
    v_mov_b32 v241, -1
    v_mov_b32 v242, -1
    v_mov_b32 v243, -1
    buffer_store_dwordx4 v[240:243], v245, s[20:23], s58 offen sc1
    buffer_store_dwordx4 v[240:243], v245, s[20:23], s58 offen offset:1024 sc1
    v_mov_b32 v60, 0
    buffer_load_dword v61, v60, s[24:27], 0 offen sc1
    ds_read_b64_tr_b16 v[192:193], v5 offset:16384
    ds_read_b64_tr_b16 v[194:195], v5 offset:16896
    v_mfma_f32_32x32x16_bf16 v[80:95], v[216:219], v[224:227], v[80:95]
    ds_read_b128 v[196:199], v6 offset:32768
    ds_read_b128 v[200:203], v6 offset:36864
    v_mfma_f32_32x32x16_bf16 v[96:111], v[216:219], v[228:231], v[96:111]
    ds_read_b128 v[204:207], v6 offset:40960
    ds_read_b128 v[208:211], v6 offset:45056
    v_mfma_f32_32x32x16_bf16 v[112:127], v[216:219], v[232:235], v[112:127]
    ds_read_b64_tr_b16 v[212:213], v5 offset:24576
    ds_read_b64_tr_b16 v[214:215], v5 offset:25088
    v_mfma_f32_32x32x16_bf16 v[128:143], v[236:239], v[220:223], v[128:143]
    v_mfma_f32_32x32x16_bf16 v[144:159], v[236:239], v[224:227], v[144:159]
    v_mfma_f32_32x32x16_bf16 v[160:175], v[236:239], v[228:231], v[160:175]
    v_mfma_f32_32x32x16_bf16 v[176:191], v[236:239], v[232:235], v[176:191]
    s_cmp_lg_u32 s47, 1
    s_cbranch_scc1 A_CM_6
    v_mfma_f32_32x32x16_bf16 v[16:31], v[216:219], v[48:51], v[16:31]
    v_mfma_f32_32x32x16_bf16 v[32:47], v[236:239], v[48:51], v[32:47]
A_CM_6:
    s_waitcnt lgkmcnt(0)
    v_mfma_f32_32x32x16_bf16 v[64:79], v[192:195], v[196:199], v[64:79]
    ds_read_b64_tr_b16 v[216:217], v5 offset:18432
    ds_read_b64_tr_b16 v[218:219], v5 offset:18944
    v_mfma_f32_32x32x16_bf16 v[80:95], v[192:195], v[200:203], v[80:95]
    ds_read_b128 v[220:223], v7 offset:32768
    ds_read_b128 v[224:227], v7 offset:36864
    v_mfma_f32_32x32x16_bf16 v[96:111], v[192:195], v[204:207], v[96:111]
    ds_read_b128 v[228:231], v7 offset:40960
    ds_read_b128 v[232:235], v7 offset:45056
    v_mfma_f32_32x32x16_bf16 v[112:127], v[192:195], v[208:211], v[112:127]
    ds_read_b64_tr_b16 v[236:237], v5 offset:26624
    ds_read_b64_tr_b16 v[238:239], v5 offset:27136
    v_mfma_f32_32x32x16_bf16 v[128:143], v[212:215], v[196:199], v[128:143]
    v_mfma_f32_32x32x16_bf16 v[144:159], v[212:215], v[200:203], v[144:159]
    v_mfma_f32_32x32x16_bf16 v[160:175], v[212:215], v[204:207], v[160:175]
    v_mfma_f32_32x32x16_bf16 v[176:191], v[212:215], v[208:211], v[176:191]
    s_waitcnt lgkmcnt(0)
    v_mfma_f32_32x32x16_bf16 v[64:79], v[216:219], v[220:223], v[64:79]
    ds_read_b64_tr_b16 v[192:193], v5 offset:20480
    ds_read_b64_tr_b16 v[194:195], v5 offset:20992
    v_mfma_f32_32x32x16_bf16 v[80:95], v[216:219], v[224:227], v[80:95]
    ds_read_b128 v[196:199], v8 offset:32768
    ds_read_b128 v[200:203], v8 offset:36864
    v_mfma_f32_32x32x16_bf16 v[96:111], v[216:219], v[228:231], v[96:111]
    ds_read_b128 v[204:207], v8 offset:40960
    ds_read_b128 v[208:211], v8 offset:45056
    v_mfma_f32_32x32x16_bf16 v[112:127], v[216:219], v[232:235], v[112:127]
    ds_read_b64_tr_b16 v[212:213], v5 offset:28672
    ds_read_b64_tr_b16 v[214:215], v5 offset:29184
    v_mfma_f32_32x32x16_bf16 v[128:143], v[236:239], v[220:223], v[128:143]
    v_mfma_f32_32x32x16_bf16 v[144:159], v[236:239], v[224:227], v[144:159]
    v_mfma_f32_32x32x16_bf16 v[160:175], v[236:239], v[228:231], v[160:175]
    v_mfma_f32_32x32x16_bf16 v[176:191], v[236:239], v[232:235], v[176:191]
    s_waitcnt lgkmcnt(0)
    v_mfma_f32_32x32x16_bf16 v[64:79], v[192:195], v[196:199], v[64:79]
    ds_read_b64_tr_b16 v[216:217], v5 offset:22528
    ds_read_b64_tr_b16 v[218:219], v5 offset:23040
    v_mfma_f32_32x32x16_bf16 v[80:95], v[192:195], v[200:203], v[80:95]
    ds_read_b128 v[220:223], v9 offset:32768
    ds_read_b128 v[224:227], v9 offset:36864
    v_mfma_f32_32x32x16_bf16 v[96:111], v[192:195], v[204:207], v[96:111]
    ds_read_b128 v[228:231], v9 offset:40960
    ds_read_b128 v[232:235], v9 offset:45056
    v_mfma_f32_32x32x16_bf16 v[112:127], v[192:195], v[208:211], v[112:127]
    ds_read_b64_tr_b16 v[236:237], v5 offset:30720
    ds_read_b64_tr_b16 v[238:239], v5 offset:31232
    v_mfma_f32_32x32x16_bf16 v[128:143], v[212:215], v[196:199], v[128:143]
    v_mfma_f32_32x32x16_bf16 v[144:159], v[212:215], v[200:203], v[144:159]
    v_mfma_f32_32x32x16_bf16 v[160:175], v[212:215], v[204:207], v[160:175]
    v_mfma_f32_32x32x16_bf16 v[176:191], v[212:215], v[208:211], v[176:191]
    s_waitcnt lgkmcnt(0)
    v_mfma_f32_32x32x16_bf16 v[64:79], v[216:219], v[220:223], v[64:79]
    v_lshrrev_b32 v58, 5, v1
    v_lshlrev_b32 v58, 4, v58
    s_lshl_b32 s41, s47, 9
    s_lshl_b32 s46, s48, 7
    s_add_u32 s41, s41, s46
    s_add_u32 s41, s41, 147456
    v_add_u32 v58, s41, v58
    s_mov_b32 exec_lo, 1
    s_mov_b32 exec_hi, 1
    ds_write_b128 v58, v[16:19] offset:0
    ds_write_b128 v58, v[20:23] offset:32
    ds_write_b128 v58, v[24:27] offset:64
    ds_write_b128 v58, v[28:31] offset:96
    ds_write_b128 v58, v[32:35] offset:256
    ds_write_b128 v58, v[36:39] offset:288
    ds_write_b128 v58, v[40:43] offset:320
    ds_write_b128 v58, v[44:47] offset:352
    s_mov_b64 exec, -1
    s_waitcnt lgkmcnt(0)
    s_barrier
    s_cmp_ge_u32 s36, 2
    s_cbranch_scc1 A_CP_7
    v_lshlrev_b32 v58, 2, v0
    v_add_u32 v59, 147456, v58
    ds_read_b32 v56, v59
    ds_read_b32 v57, v59 offset:512
    s_lshl_b32 s41, s40, 3
    s_add_u32 s41, s41, s39
    s_lshl_b32 s41, s41, 9
    s_add_u32 s41, s41, 13402112
    s_waitcnt lgkmcnt(0)
    v_add_f32 v56, v56, v57
    buffer_store_dword v56, v58, s[20:23], s41 offen sc1
A_CP_7:
    s_cmp_lg_u32 s36, 2
    s_cbranch_scc1 W_8
    v_and_b32 v58, 15, v1
    v_lshlrev_b32 v58, 2, v58
    v_add_u32 v59, 148480, v58
    ds_read_b32 v56, v59
    s_lshl_b32 s41, s53, 6
    s_add_u32 s41, s41, 13385728
    s_waitcnt lgkmcnt(0)
    s_mov_b64 exec, 0xffff
    buffer_store_dword v56, v58, s[20:23], s41 offen sc1
    s_mov_b64 exec, -1
W_8:
    ds_read_b64_tr_b16 v[192:193], v5 offset:32768
    ds_read_b64_tr_b16 v[194:195], v5 offset:33280
    v_mfma_f32_32x32x16_bf16 v[80:95], v[216:219], v[224:227], v[80:95]
    ds_read_b128 v[196:199], v10 offset:0
    ds_read_b128 v[200:203], v10 offset:4096
    v_mfma_f32_32x32x16_bf16 v[96:111], v[216:219], v[228:231], v[96:111]
    ds_read_b128 v[204:207], v10 offset:8192
    ds_read_b128 v[208:211], v10 offset:12288
    v_mfma_f32_32x32x16_bf16 v[112:127], v[216:219], v[232:235], v[112:127]
    ds_read_b64_tr_b16 v[212:213], v5 offset:40960
    ds_read_b64_tr_b16 v[214:215], v5 offset:41472
    v_mfma_f32_32x32x16_bf16 v[128:143], v[236:239], v[220:223], v[128:143]
    v_mfma_f32_32x32x16_bf16 v[144:159], v[236:239], v[224:227], v[144:159]
    v_mfma_f32_32x32x16_bf16 v[160:175], v[236:239], v[228:231], v[160:175]
    v_mfma_f32_32x32x16_bf16 v[176:191], v[236:239], v[232:235], v[176:191]
    s_waitcnt lgkmcnt(0)
    v_mfma_f32_32x32x16_bf16 v[64:79], v[192:195], v[196:199], v[64:79]
    ds_read_b64_tr_b16 v[216:217], v5 offset:34816
    ds_read_b64_tr_b16 v[218:219], v5 offset:35328
    v_mfma_f32_32x32x16_bf16 v[80:95], v[192:195], v[200:203], v[80:95]
    ds_read_b128 v[220:223], v11 offset:0
    ds_read_b128 v[224:227], v11 offset:4096
    v_mfma_f32_32x32x16_bf16 v[96:111], v[192:195], v[204:207], v[96:111]
    ds_read_b128 v[228:231], v11 offset:8192
    ds_read_b128 v[232:235], v11 offset:12288
    v_mfma_f32_32x32x16_bf16 v[112:127], v[192:195], v[208:211], v[112:127]
    ds_read_b64_tr_b16 v[236:237], v5 offset:43008
    ds_read_b64_tr_b16 v[238:239], v5 offset:43520
    v_mfma_f32_32x32x16_bf16 v[128:143], v[212:215], v[196:199], v[128:143]
    v_mfma_f32_32x32x16_bf16 v[144:159], v[212:215], v[200:203], v[144:159]
    v_mfma_f32_32x32x16_bf16 v[160:175], v[212:215], v[204:207], v[160:175]
    v_mfma_f32_32x32x16_bf16 v[176:191], v[212:215], v[208:211], v[176:191]
    s_waitcnt lgkmcnt(0)
    v_mfma_f32_32x32x16_bf16 v[64:79], v[216:219], v[220:223], v[64:79]
    ds_read_b64_tr_b16 v[192:193], v5 offset:36864
    ds_read_b64_tr_b16 v[194:195], v5 offset:37376
    v_mfma_f32_32x32x16_bf16 v[80:95], v[216:219], v[224:227], v[80:95]
    ds_read_b128 v[196:199], v12 offset:0
    ds_read_b128 v[200:203], v12 offset:4096
    v_mfma_f32_32x32x16_bf16 v[96:111], v[216:219], v[228:231], v[96:111]
    ds_read_b128 v[204:207], v12 offset:8192
    ds_read_b128 v[208:211], v12 offset:12288
    v_mfma_f32_32x32x16_bf16 v[112:127], v[216:219], v[232:235], v[112:127]
    ds_read_b64_tr_b16 v[212:213], v5 offset:45056
    ds_read_b64_tr_b16 v[214:215], v5 offset:45568
    v_mfma_f32_32x32x16_bf16 v[128:143], v[236:239], v[220:223], v[128:143]
    v_mfma_f32_32x32x16_bf16 v[144:159], v[236:239], v[224:227], v[144:159]
    v_mfma_f32_32x32x16_bf16 v[160:175], v[236:239], v[228:231], v[160:175]
    v_mfma_f32_32x32x16_bf16 v[176:191], v[236:239], v[232:235], v[176:191]
    s_waitcnt lgkmcnt(0)
    v_mfma_f32_32x32x16_bf16 v[64:79], v[192:195], v[196:199], v[64:79]
    ds_read_b64_tr_b16 v[216:217], v5 offset:38912
    ds_read_b64_tr_b16 v[218:219], v5 offset:39424
    v_mfma_f32_32x32x16_bf16 v[80:95], v[192:195], v[200:203], v[80:95]
    ds_read_b128 v[220:223], v13 offset:0
    ds_read_b128 v[224:227], v13 offset:4096
    v_mfma_f32_32x32x16_bf16 v[96:111], v[192:195], v[204:207], v[96:111]
    ds_read_b128 v[228:231], v13 offset:8192
    ds_read_b128 v[232:235], v13 offset:12288
    v_mfma_f32_32x32x16_bf16 v[112:127], v[192:195], v[208:211], v[112:127]
    ds_read_b64_tr_b16 v[236:237], v5 offset:47104
    ds_read_b64_tr_b16 v[238:239], v5 offset:47616
    v_mfma_f32_32x32x16_bf16 v[128:143], v[212:215], v[196:199], v[128:143]
    v_mfma_f32_32x32x16_bf16 v[144:159], v[212:215], v[200:203], v[144:159]
    v_mfma_f32_32x32x16_bf16 v[160:175], v[212:215], v[204:207], v[160:175]
    v_mfma_f32_32x32x16_bf16 v[176:191], v[212:215], v[208:211], v[176:191]
    s_waitcnt lgkmcnt(0)
    v_mfma_f32_32x32x16_bf16 v[64:79], v[216:219], v[220:223], v[64:79]
    s_waitcnt vmcnt(0)
    s_barrier
    s_cmp_lg_u32 s36, 0
    s_cbranch_scc1 W0_9
A_INIT:
    v_readfirstlane_b32 s41, v61
    s_nop 0
    s_cmp_lg_u32 s41, 0
    s_cbranch_scc1 A_INIT_OK
    s_sleep 8
    v_mov_b32 v18, 0
    buffer_load_dword v61, v18, s[24:27], 0 offen sc1
    s_waitcnt vmcnt(0)
    s_branch A_INIT
A_INIT_OK:
    s_lshl_b32 s41, s37, 7
    s_lshl_b32 s46, s38, 2
    s_add_u32 s41, s41, s46
    s_add_u32 s41, s41, 13371392
    v_mov_b32 v16, s41
    s_lshl_b32 s41, s40, 7
    s_lshl_b32 s46, s39, 2
    s_add_u32 s41, s41, s46
    s_add_u32 s41, s41, 13373440
    v_mov_b32 v17, s41
    v_cmp_eq_u32 vcc, 1, v1
    s_nop 1
    v_cndmask_b32 v16, v16, v17, vcc
    s_lshr_b32 s41, s2, 5
    s_lshl_b32 s41, s41, 7
    s_and_b32 s46, s2, 31
    s_lshl_b32 s46, s46, 2
    s_add_u32 s41, s41, s46
    s_add_u32 s41, s41, 13372416
    v_mov_b32 v17, s41
    v_cmp_eq_u32 vcc, 2, v1
    s_nop 1
    v_cndmask_b32 v16, v16, v17, vcc
    v_mov_b32 v17, s90
    s_mov_b64 exec, 7
    buffer_store_dword v17, v16, s[20:23], 0 offen sc1
    s_mov_b64 exec, -1
W0_9:
    ds_read_b64_tr_b16 v[192:193], v5 offset:0
    ds_read_b64_tr_b16 v[194:195], v5 offset:512
    v_mfma_f32_32x32x16_bf16 v[80:95], v[216:219], v[224:227], v[80:95]
    ds_read_b128 v[196:199], v6 offset:0
    ds_read_b128 v[200:203], v6 offset:4096
    v_mfma_f32_32x32x16_bf16 v[96:111], v[216:219], v[228:231], v[96:111]
    ds_read_b128 v[204:207], v6 offset:8192
    ds_read_b128 v[208:211], v6 offset:12288
    v_mfma_f32_32x32x16_bf16 v[112:127], v[216:219], v[232:235], v[112:127]
    ds_read_b64_tr_b16 v[212:213], v5 offset:8192
    ds_read_b64_tr_b16 v[214:215], v5 offset:8704
    v_mfma_f32_32x32x16_bf16 v[128:143], v[236:239], v[220:223], v[128:143]
    v_mfma_f32_32x32x16_bf16 v[144:159], v[236:239], v[224:227], v[144:159]
    v_mfma_f32_32x32x16_bf16 v[160:175], v[236:239], v[228:231], v[160:175]
    v_mfma_f32_32x32x16_bf16 v[176:191], v[236:239], v[232:235], v[176:191]
    s_waitcnt lgkmcnt(0)
    v_mfma_f32_32x32x16_bf16 v[64:79], v[192:195], v[196:199], v[64:79]
    ds_read_b64_tr_b16 v[216:217], v5 offset:2048
    ds_read_b64_tr_b16 v[218:219], v5 offset:2560
    v_mfma_f32_32x32x16_bf16 v[80:95], v[192:195], v[200:203], v[80:95]
    ds_read_b128 v[220:223], v7 offset:0
    ds_read_b128 v[224:227], v7 offset:4096
    v_mfma_f32_32x32x16_bf16 v[96:111], v[192:195], v[204:207], v[96:111]
    ds_read_b128 v[228:231], v7 offset:8192
    ds_read_b128 v[232:235], v7 offset:12288
    v_mfma_f32_32x32x16_bf16 v[112:127], v[192:195], v[208:211], v[112:127]
    ds_read_b64_tr_b16 v[236:237], v5 offset:10240
    ds_read_b64_tr_b16 v[238:239], v5 offset:10752
    v_mfma_f32_32x32x16_bf16 v[128:143], v[212:215], v[196:199], v[128:143]
    v_mfma_f32_32x32x16_bf16 v[144:159], v[212:215], v[200:203], v[144:159]
    v_mfma_f32_32x32x16_bf16 v[160:175], v[212:215], v[204:207], v[160:175]
    v_mfma_f32_32x32x16_bf16 v[176:191], v[212:215], v[208:211], v[176:191]
    s_waitcnt lgkmcnt(0)
    v_mfma_f32_32x32x16_bf16 v[64:79], v[216:219], v[220:223], v[64:79]
    ds_read_b64_tr_b16 v[192:193], v5 offset:4096
    ds_read_b64_tr_b16 v[194:195], v5 offset:4608
    v_mfma_f32_32x32x16_bf16 v[80:95], v[216:219], v[224:227], v[80:95]
    ds_read_b128 v[196:199], v8 offset:0
    ds_read_b128 v[200:203], v8 offset:4096
    v_mfma_f32_32x32x16_bf16 v[96:111], v[216:219], v[228:231], v[96:111]
    ds_read_b128 v[204:207], v8 offset:8192
    ds_read_b128 v[208:211], v8 offset:12288
    v_mfma_f32_32x32x16_bf16 v[112:127], v[216:219], v[232:235], v[112:127]
    ds_read_b64_tr_b16 v[212:213], v5 offset:12288
    ds_read_b64_tr_b16 v[214:215], v5 offset:12800
    v_mfma_f32_32x32x16_bf16 v[128:143], v[236:239], v[220:223], v[128:143]
    v_mfma_f32_32x32x16_bf16 v[144:159], v[236:239], v[224:227], v[144:159]
    v_mfma_f32_32x32x16_bf16 v[160:175], v[236:239], v[228:231], v[160:175]
    v_mfma_f32_32x32x16_bf16 v[176:191], v[236:239], v[232:235], v[176:191]
    s_waitcnt lgkmcnt(0)
    v_mfma_f32_32x32x16_bf16 v[64:79], v[192:195], v[196:199], v[64:79]
    ds_read_b64_tr_b16 v[216:217], v5 offset:6144
    ds_read_b64_tr_b16 v[218:219], v5 offset:6656
    v_mfma_f32_32x32x16_bf16 v[80:95], v[192:195], v[200:203], v[80:95]
    ds_read_b128 v[220:223], v9 offset:0
    ds_read_b128 v[224:227], v9 offset:4096
    v_mfma_f32_32x32x16_bf16 v[96:111], v[192:195], v[204:207], v[96:111]
    ds_read_b128 v[228:231], v9 offset:8192
    ds_read_b128 v[232:235], v9 offset:12288
    v_mfma_f32_32x32x16_bf16 v[112:127], v[192:195], v[208:211], v[112:127]
    ds_read_b64_tr_b16 v[236:237], v5 offset:14336
    ds_read_b64_tr_b16 v[238:239], v5 offset:14848
    v_mfma_f32_32x32x16_bf16 v[128:143], v[212:215], v[196:199], v[128:143]
    v_mfma_f32_32x32x16_bf16 v[144:159], v[212:215], v[200:203], v[144:159]
    v_mfma_f32_32x32x16_bf16 v[160:175], v[212:215], v[204:207], v[160:175]
    v_mfma_f32_32x32x16_bf16 v[176:191], v[212:215], v[208:211], v[176:191]
    s_waitcnt lgkmcnt(0)
    v_mfma_f32_32x32x16_bf16 v[64:79], v[216:219], v[220:223], v[64:79]
    s_barrier
    ds_read_b64_tr_b16 v[192:193], v5 offset:16384
    ds_read_b64_tr_b16 v[194:195], v5 offset:16896
    v_mfma_f32_32x32x16_bf16 v[80:95], v[216:219], v[224:227], v[80:95]
    ds_read_b128 v[196:199], v6 offset:32768
    ds_read_b128 v[200:203], v6 offset:36864
    v_mfma_f32_32x32x16_bf16 v[96:111], v[216:219], v[228:231], v[96:111]
    ds_read_b128 v[204:207], v6 offset:40960
    ds_read_b128 v[208:211], v6 offset:45056
    v_mfma_f32_32x32x16_bf16 v[112:127], v[216:219], v[232:235], v[112:127]
    ds_read_b64_tr_b16 v[212:213], v5 offset:24576
    ds_read_b64_tr_b16 v[214:215], v5 offset:25088
    v_mfma_f32_32x32x16_bf16 v[128:143], v[236:239], v[220:223], v[128:143]
    v_mfma_f32_32x32x16_bf16 v[144:159], v[236:239], v[224:227], v[144:159]
    v_mfma_f32_32x32x16_bf16 v[160:175], v[236:239], v[228:231], v[160:175]
    v_mfma_f32_32x32x16_bf16 v[176:191], v[236:239], v[232:235], v[176:191]
    s_waitcnt lgkmcnt(0)
    v_mfma_f32_32x32x16_bf16 v[64:79], v[192:195], v[196:199], v[64:79]
    ds_read_b64_tr_b16 v[216:217], v5 offset:18432
    ds_read_b64_tr_b16 v[218:219], v5 offset:18944
    v_mfma_f32_32x32x16_bf16 v[80:95], v[192:195], v[200:203], v[80:95]
    ds_read_b128 v[220:223], v7 offset:32768
    ds_read_b128 v[224:227], v7 offset:36864
    v_mfma_f32_32x32x16_bf16 v[96:111], v[192:195], v[204:207], v[96:111]
    ds_read_b128 v[228:231], v7 offset:40960
    ds_read_b128 v[232:235], v7 offset:45056
    v_mfma_f32_32x32x16_bf16 v[112:127], v[192:195], v[208:211], v[112:127]
    ds_read_b64_tr_b16 v[236:237], v5 offset:26624
    ds_read_b64_tr_b16 v[238:239], v5 offset:27136
    v_mfma_f32_32x32x16_bf16 v[128:143], v[212:215], v[196:199], v[128:143]
    v_mfma_f32_32x32x16_bf16 v[144:159], v[212:215], v[200:203], v[144:159]
    v_mfma_f32_32x32x16_bf16 v[160:175], v[212:215], v[204:207], v[160:175]
    v_mfma_f32_32x32x16_bf16 v[176:191], v[212:215], v[208:211], v[176:191]
    s_waitcnt lgkmcnt(0)
    v_mfma_f32_32x32x16_bf16 v[64:79], v[216:219], v[220:223], v[64:79]
    ds_read_b64_tr_b16 v[192:193], v5 offset:20480
    ds_read_b64_tr_b16 v[194:195], v5 offset:20992
    v_mfma_f32_32x32x16_bf16 v[80:95], v[216:219], v[224:227], v[80:95]
    ds_read_b128 v[196:199], v8 offset:32768
    ds_read_b128 v[200:203], v8 offset:36864
    v_mfma_f32_32x32x16_bf16 v[96:111], v[216:219], v[228:231], v[96:111]
    ds_read_b128 v[204:207], v8 offset:40960
    ds_read_b128 v[208:211], v8 offset:45056
    v_mfma_f32_32x32x16_bf16 v[112:127], v[216:219], v[232:235], v[112:127]
    ds_read_b64_tr_b16 v[212:213], v5 offset:28672
    ds_read_b64_tr_b16 v[214:215], v5 offset:29184
    v_mfma_f32_32x32x16_bf16 v[128:143], v[236:239], v[220:223], v[128:143]
    v_mfma_f32_32x32x16_bf16 v[144:159], v[236:239], v[224:227], v[144:159]
    v_mfma_f32_32x32x16_bf16 v[160:175], v[236:239], v[228:231], v[160:175]
    v_mfma_f32_32x32x16_bf16 v[176:191], v[236:239], v[232:235], v[176:191]
    s_waitcnt lgkmcnt(0)
    v_mfma_f32_32x32x16_bf16 v[64:79], v[192:195], v[196:199], v[64:79]
    ds_read_b64_tr_b16 v[216:217], v5 offset:22528
    ds_read_b64_tr_b16 v[218:219], v5 offset:23040
    v_mfma_f32_32x32x16_bf16 v[80:95], v[192:195], v[200:203], v[80:95]
    ds_read_b128 v[220:223], v9 offset:32768
    ds_read_b128 v[224:227], v9 offset:36864
    v_mfma_f32_32x32x16_bf16 v[96:111], v[192:195], v[204:207], v[96:111]
    ds_read_b128 v[228:231], v9 offset:40960
    ds_read_b128 v[232:235], v9 offset:45056
    v_mfma_f32_32x32x16_bf16 v[112:127], v[192:195], v[208:211], v[112:127]
    ds_read_b64_tr_b16 v[236:237], v5 offset:30720
    ds_read_b64_tr_b16 v[238:239], v5 offset:31232
    v_mfma_f32_32x32x16_bf16 v[128:143], v[212:215], v[196:199], v[128:143]
    v_mfma_f32_32x32x16_bf16 v[144:159], v[212:215], v[200:203], v[144:159]
    v_mfma_f32_32x32x16_bf16 v[160:175], v[212:215], v[204:207], v[160:175]
    v_mfma_f32_32x32x16_bf16 v[176:191], v[212:215], v[208:211], v[176:191]
    s_waitcnt lgkmcnt(0)
    v_mfma_f32_32x32x16_bf16 v[64:79], v[216:219], v[220:223], v[64:79]
    s_barrier
    ds_read_b64_tr_b16 v[192:193], v5 offset:32768
    ds_read_b64_tr_b16 v[194:195], v5 offset:33280
    v_mfma_f32_32x32x16_bf16 v[80:95], v[216:219], v[224:227], v[80:95]
    ds_read_b128 v[196:199], v10 offset:0
    ds_read_b128 v[200:203], v10 offset:4096
    v_mfma_f32_32x32x16_bf16 v[96:111], v[216:219], v[228:231], v[96:111]
    ds_read_b128 v[204:207], v10 offset:8192
    ds_read_b128 v[208:211], v10 offset:12288
    v_mfma_f32_32x32x16_bf16 v[112:127], v[216:219], v[232:235], v[112:127]
    ds_read_b64_tr_b16 v[212:213], v5 offset:40960
    ds_read_b64_tr_b16 v[214:215], v5 offset:41472
    v_mfma_f32_32x32x16_bf16 v[128:143], v[236:239], v[220:223], v[128:143]
    v_mfma_f32_32x32x16_bf16 v[144:159], v[236:239], v[224:227], v[144:159]
    v_mfma_f32_32x32x16_bf16 v[160:175], v[236:239], v[228:231], v[160:175]
    v_mfma_f32_32x32x16_bf16 v[176:191], v[236:239], v[232:235], v[176:191]
    s_waitcnt lgkmcnt(0)
    v_mfma_f32_32x32x16_bf16 v[64:79], v[192:195], v[196:199], v[64:79]
    ds_read_b64_tr_b16 v[216:217], v5 offset:34816
    ds_read_b64_tr_b16 v[218:219], v5 offset:35328
    v_mfma_f32_32x32x16_bf16 v[80:95], v[192:195], v[200:203], v[80:95]
    ds_read_b128 v[220:223], v11 offset:0
    ds_read_b128 v[224:227], v11 offset:4096
    v_mfma_f32_32x32x16_bf16 v[96:111], v[192:195], v[204:207], v[96:111]
    ds_read_b128 v[228:231], v11 offset:8192
    ds_read_b128 v[232:235], v11 offset:12288
    v_mfma_f32_32x32x16_bf16 v[112:127], v[192:195], v[208:211], v[112:127]
    ds_read_b64_tr_b16 v[236:237], v5 offset:43008
    ds_read_b64_tr_b16 v[238:239], v5 offset:43520
    v_mfma_f32_32x32x16_bf16 v[128:143], v[212:215], v[196:199], v[128:143]
    v_mfma_f32_32x32x16_bf16 v[144:159], v[212:215], v[200:203], v[144:159]
    v_mfma_f32_32x32x16_bf16 v[160:175], v[212:215], v[204:207], v[160:175]
    v_mfma_f32_32x32x16_bf16 v[176:191], v[212:215], v[208:211], v[176:191]
    s_waitcnt lgkmcnt(0)
    v_mfma_f32_32x32x16_bf16 v[64:79], v[216:219], v[220:223], v[64:79]
    ds_read_b64_tr_b16 v[192:193], v5 offset:36864
    ds_read_b64_tr_b16 v[194:195], v5 offset:37376
    v_mfma_f32_32x32x16_bf16 v[80:95], v[216:219], v[224:227], v[80:95]
    ds_read_b128 v[196:199], v12 offset:0
    ds_read_b128 v[200:203], v12 offset:4096
    v_mfma_f32_32x32x16_bf16 v[96:111], v[216:219], v[228:231], v[96:111]
    ds_read_b128 v[204:207], v12 offset:8192
    ds_read_b128 v[208:211], v12 offset:12288
    v_mfma_f32_32x32x16_bf16 v[112:127], v[216:219], v[232:235], v[112:127]
    ds_read_b64_tr_b16 v[212:213], v5 offset:45056
    ds_read_b64_tr_b16 v[214:215], v5 offset:45568
    v_mfma_f32_32x32x16_bf16 v[128:143], v[236:239], v[220:223], v[128:143]
    v_mfma_f32_32x32x16_bf16 v[144:159], v[236:239], v[224:227], v[144:159]
    v_mfma_f32_32x32x16_bf16 v[160:175], v[236:239], v[228:231], v[160:175]
    v_mfma_f32_32x32x16_bf16 v[176:191], v[236:239], v[232:235], v[176:191]
    s_waitcnt lgkmcnt(0)
    v_mfma_f32_32x32x16_bf16 v[64:79], v[192:195], v[196:199], v[64:79]
    ds_read_b64_tr_b16 v[216:217], v5 offset:38912
    ds_read_b64_tr_b16 v[218:219], v5 offset:39424
    v_mfma_f32_32x32x16_bf16 v[80:95], v[192:195], v[200:203], v[80:95]
    ds_read_b128 v[220:223], v13 offset:0
    ds_read_b128 v[224:227], v13 offset:4096
    v_mfma_f32_32x32x16_bf16 v[96:111], v[192:195], v[204:207], v[96:111]
    ds_read_b128 v[228:231], v13 offset:8192
    ds_read_b128 v[232:235], v13 offset:12288
    v_mfma_f32_32x32x16_bf16 v[112:127], v[192:195], v[208:211], v[112:127]
    ds_read_b64_tr_b16 v[236:237], v5 offset:47104
    ds_read_b64_tr_b16 v[238:239], v5 offset:47616
    v_mfma_f32_32x32x16_bf16 v[128:143], v[212:215], v[196:199], v[128:143]
    v_mfma_f32_32x32x16_bf16 v[144:159], v[212:215], v[200:203], v[144:159]
    v_mfma_f32_32x32x16_bf16 v[160:175], v[212:215], v[204:207], v[160:175]
    v_mfma_f32_32x32x16_bf16 v[176:191], v[212:215], v[208:211], v[176:191]
    s_waitcnt lgkmcnt(0)
    v_mfma_f32_32x32x16_bf16 v[64:79], v[216:219], v[220:223], v[64:79]
    s_barrier
    v_and_b32 v14, 31, v1
    v_lshlrev_b32 v14, 3, v14
    s_lshl_b32 s41, s39, 11
    s_lshl_b32 s46, s47, 10
    s_add_u32 s41, s41, s46
    s_add_u32 s41, s41, 13385728
    buffer_load_dwordx2 v[52:53], v14, s[20:23], s41 offen offset:0 sc1
    buffer_load_dwordx2 v[54:55], v14, s[20:23], s41 offen offset:256 sc1
    buffer_load_dwordx2 v[56:57], v14, s[20:23], s41 offen offset:512 sc1
    buffer_load_dwordx2 v[58:59], v14, s[20:23], s41 offen offset:768 sc1
    ds_read_b64_tr_b16 v[192:193], v5 offset:0
    ds_read_b64_tr_b16 v[194:195], v5 offset:512
    v_mfma_f32_32x32x16_bf16 v[80:95], v[216:219], v[224:227], v[80:95]
    ds_read_b128 v[196:199], v6 offset:0
    ds_read_b128 v[200:203], v6 offset:4096
    v_mfma_f32_32x32x16_bf16 v[96:111], v[216:219], v[228:231], v[96:111]
    ds_read_b128 v[204:207], v6 offset:8192
    ds_read_b128 v[208:211], v6 offset:12288
    v_mfma_f32_32x32x16_bf16 v[112:127], v[216:219], v[232:235], v[112:127]
    ds_read_b64_tr_b16 v[212:213], v5 offset:8192
    ds_read_b64_tr_b16 v[214:215], v5 offset:8704
    v_mfma_f32_32x32x16_bf16 v[128:143], v[236:239], v[220:223], v[128:143]
    v_mfma_f32_32x32x16_bf16 v[144:159], v[236:239], v[224:227], v[144:159]
    v_mfma_f32_32x32x16_bf16 v[160:175], v[236:239], v[228:231], v[160:175]
    v_mfma_f32_32x32x16_bf16 v[176:191], v[236:239], v[232:235], v[176:191]
    s_waitcnt lgkmcnt(0)
    v_mfma_f32_32x32x16_bf16 v[64:79], v[192:195], v[196:199], v[64:79]
    ds_read_b64_tr_b16 v[216:217], v5 offset:2048
    ds_read_b64_tr_b16 v[218:219], v5 offset:2560
    v_mfma_f32_32x32x16_bf16 v[80:95], v[192:195], v[200:203], v[80:95]
    ds_read_b128 v[220:223], v7 offset:0
    ds_read_b128 v[224:227], v7 offset:4096
    v_mfma_f32_32x32x16_bf16 v[96:111], v[192:195], v[204:207], v[96:111]
    ds_read_b128 v[228:231], v7 offset:8192
    ds_read_b128 v[232:235], v7 offset:12288
    v_mfma_f32_32x32x16_bf16 v[112:127], v[192:195], v[208:211], v[112:127]
    ds_read_b64_tr_b16 v[236:237], v5 offset:10240
    ds_read_b64_tr_b16 v[238:239], v5 offset:10752
    v_mfma_f32_32x32x16_bf16 v[128:143], v[212:215], v[196:199], v[128:143]
    v_mfma_f32_32x32x16_bf16 v[144:159], v[212:215], v[200:203], v[144:159]
    v_mfma_f32_32x32x16_bf16 v[160:175], v[212:215], v[204:207], v[160:175]
    v_mfma_f32_32x32x16_bf16 v[176:191], v[212:215], v[208:211], v[176:191]
    s_waitcnt lgkmcnt(0)
    v_mfma_f32_32x32x16_bf16 v[64:79], v[216:219], v[220:223], v[64:79]
    ds_read_b64_tr_b16 v[192:193], v5 offset:4096
    ds_read_b64_tr_b16 v[194:195], v5 offset:4608
    v_mfma_f32_32x32x16_bf16 v[80:95], v[216:219], v[224:227], v[80:95]
    ds_read_b128 v[196:199], v8 offset:0
    ds_read_b128 v[200:203], v8 offset:4096
    v_mfma_f32_32x32x16_bf16 v[96:111], v[216:219], v[228:231], v[96:111]
    ds_read_b128 v[204:207], v8 offset:8192
    ds_read_b128 v[208:211], v8 offset:12288
    v_mfma_f32_32x32x16_bf16 v[112:127], v[216:219], v[232:235], v[112:127]
    ds_read_b64_tr_b16 v[212:213], v5 offset:12288
    ds_read_b64_tr_b16 v[214:215], v5 offset:12800
    v_mfma_f32_32x32x16_bf16 v[128:143], v[236:239], v[220:223], v[128:143]
    v_mfma_f32_32x32x16_bf16 v[144:159], v[236:239], v[224:227], v[144:159]
    v_mfma_f32_32x32x16_bf16 v[160:175], v[236:239], v[228:231], v[160:175]
    v_mfma_f32_32x32x16_bf16 v[176:191], v[236:239], v[232:235], v[176:191]
    s_waitcnt lgkmcnt(0)
    v_mfma_f32_32x32x16_bf16 v[64:79], v[192:195], v[196:199], v[64:79]
    ds_read_b64_tr_b16 v[216:217], v5 offset:6144
    ds_read_b64_tr_b16 v[218:219], v5 offset:6656
    v_mfma_f32_32x32x16_bf16 v[80:95], v[192:195], v[200:203], v[80:95]
    ds_read_b128 v[220:223], v9 offset:0
    ds_read_b128 v[224:227], v9 offset:4096
    v_mfma_f32_32x32x16_bf16 v[96:111], v[192:195], v[204:207], v[96:111]
    ds_read_b128 v[228:231], v9 offset:8192
    ds_read_b128 v[232:235], v9 offset:12288
    v_mfma_f32_32x32x16_bf16 v[112:127], v[192:195], v[208:211], v[112:127]
    ds_read_b64_tr_b16 v[236:237], v5 offset:14336
    ds_read_b64_tr_b16 v[238:239], v5 offset:14848
    v_mfma_f32_32x32x16_bf16 v[128:143], v[212:215], v[196:199], v[128:143]
    v_mfma_f32_32x32x16_bf16 v[144:159], v[212:215], v[200:203], v[144:159]
    v_mfma_f32_32x32x16_bf16 v[160:175], v[212:215], v[204:207], v[160:175]
    v_mfma_f32_32x32x16_bf16 v[176:191], v[212:215], v[208:211], v[176:191]
    s_waitcnt lgkmcnt(0)
    v_mfma_f32_32x32x16_bf16 v[64:79], v[216:219], v[220:223], v[64:79]
    s_barrier
    ds_read_b64_tr_b16 v[192:193], v5 offset:16384
    ds_read_b64_tr_b16 v[194:195], v5 offset:16896
    v_mfma_f32_32x32x16_bf16 v[80:95], v[216:219], v[224:227], v[80:95]
    ds_read_b128 v[196:199], v6 offset:32768
    ds_read_b128 v[200:203], v6 offset:36864
    v_mfma_f32_32x32x16_bf16 v[96:111], v[216:219], v[228:231], v[96:111]
    ds_read_b128 v[204:207], v6 offset:40960
    ds_read_b128 v[208:211], v6 offset:45056
    v_mfma_f32_32x32x16_bf16 v[112:127], v[216:219], v[232:235], v[112:127]
    ds_read_b64_tr_b16 v[212:213], v5 offset:24576
    ds_read_b64_tr_b16 v[214:215], v5 offset:25088
    v_mfma_f32_32x32x16_bf16 v[128:143], v[236:239], v[220:223], v[128:143]
    v_mfma_f32_32x32x16_bf16 v[144:159], v[236:239], v[224:227], v[144:159]
    v_mfma_f32_32x32x16_bf16 v[160:175], v[236:239], v[228:231], v[160:175]
    v_mfma_f32_32x32x16_bf16 v[176:191], v[236:239], v[232:235], v[176:191]
    s_waitcnt lgkmcnt(0)
    v_mfma_f32_32x32x16_bf16 v[64:79], v[192:195], v[196:199], v[64:79]
    ds_read_b64_tr_b16 v[216:217], v5 offset:18432
    ds_read_b64_tr_b16 v[218:219], v5 offset:18944
    v_mfma_f32_32x32x16_bf16 v[80:95], v[192:195], v[200:203], v[80:95]
    ds_read_b128 v[220:223], v7 offset:32768
    ds_read_b128 v[224:227], v7 offset:36864
    v_mfma_f32_32x32x16_bf16 v[96:111], v[192:195], v[204:207], v[96:111]
    ds_read_b128 v[228:231], v7 offset:40960
    ds_read_b128 v[232:235], v7 offset:45056
    v_mfma_f32_32x32x16_bf16 v[112:127], v[192:195], v[208:211], v[112:127]
    ds_read_b64_tr_b16 v[236:237], v5 offset:26624
    ds_read_b64_tr_b16 v[238:239], v5 offset:27136
    v_mfma_f32_32x32x16_bf16 v[128:143], v[212:215], v[196:199], v[128:143]
    v_mfma_f32_32x32x16_bf16 v[144:159], v[212:215], v[200:203], v[144:159]
    v_mfma_f32_32x32x16_bf16 v[160:175], v[212:215], v[204:207], v[160:175]
    v_mfma_f32_32x32x16_bf16 v[176:191], v[212:215], v[208:211], v[176:191]
    s_waitcnt lgkmcnt(0)
    v_mfma_f32_32x32x16_bf16 v[64:79], v[216:219], v[220:223], v[64:79]
    ds_read_b64_tr_b16 v[192:193], v5 offset:20480
    ds_read_b64_tr_b16 v[194:195], v5 offset:20992
    v_mfma_f32_32x32x16_bf16 v[80:95], v[216:219], v[224:227], v[80:95]
    ds_read_b128 v[196:199], v8 offset:32768
    ds_read_b128 v[200:203], v8 offset:36864
    v_mfma_f32_32x32x16_bf16 v[96:111], v[216:219], v[228:231], v[96:111]
    ds_read_b128 v[204:207], v8 offset:40960
    ds_read_b128 v[208:211], v8 offset:45056
    v_mfma_f32_32x32x16_bf16 v[112:127], v[216:219], v[232:235], v[112:127]
    ds_read_b64_tr_b16 v[212:213], v5 offset:28672
    ds_read_b64_tr_b16 v[214:215], v5 offset:29184
    v_mfma_f32_32x32x16_bf16 v[128:143], v[236:239], v[220:223], v[128:143]
    v_mfma_f32_32x32x16_bf16 v[144:159], v[236:239], v[224:227], v[144:159]
    v_mfma_f32_32x32x16_bf16 v[160:175], v[236:239], v[228:231], v[160:175]
    v_mfma_f32_32x32x16_bf16 v[176:191], v[236:239], v[232:235], v[176:191]
    s_waitcnt lgkmcnt(0)
    v_mfma_f32_32x32x16_bf16 v[64:79], v[192:195], v[196:199], v[64:79]
    ds_read_b64_tr_b16 v[216:217], v5 offset:22528
    ds_read_b64_tr_b16 v[218:219], v5 offset:23040
    v_mfma_f32_32x32x16_bf16 v[80:95], v[192:195], v[200:203], v[80:95]
    ds_read_b128 v[220:223], v9 offset:32768
    ds_read_b128 v[224:227], v9 offset:36864
    v_mfma_f32_32x32x16_bf16 v[96:111], v[192:195], v[204:207], v[96:111]
    ds_read_b128 v[228:231], v9 offset:40960
    ds_read_b128 v[232:235], v9 offset:45056
    v_mfma_f32_32x32x16_bf16 v[112:127], v[192:195], v[208:211], v[112:127]
    ds_read_b64_tr_b16 v[236:237], v5 offset:30720
    ds_read_b64_tr_b16 v[238:239], v5 offset:31232
    v_mfma_f32_32x32x16_bf16 v[128:143], v[212:215], v[196:199], v[128:143]
    v_mfma_f32_32x32x16_bf16 v[144:159], v[212:215], v[200:203], v[144:159]
    v_mfma_f32_32x32x16_bf16 v[160:175], v[212:215], v[204:207], v[160:175]
    v_mfma_f32_32x32x16_bf16 v[176:191], v[212:215], v[208:211], v[176:191]
    s_waitcnt lgkmcnt(0)
    v_mfma_f32_32x32x16_bf16 v[64:79], v[216:219], v[220:223], v[64:79]
    v_mfma_f32_32x32x16_bf16 v[80:95], v[216:219], v[224:227], v[80:95]
    v_mfma_f32_32x32x16_bf16 v[96:111], v[216:219], v[228:231], v[96:111]
    v_mfma_f32_32x32x16_bf16 v[112:127], v[216:219], v[232:235], v[112:127]
    v_mfma_f32_32x32x16_bf16 v[128:143], v[236:239], v[220:223], v[128:143]
    v_mfma_f32_32x32x16_bf16 v[144:159], v[236:239], v[224:227], v[144:159]
    v_mfma_f32_32x32x16_bf16 v[160:175], v[236:239], v[228:231], v[160:175]
    v_mfma_f32_32x32x16_bf16 v[176:191], v[236:239], v[232:235], v[176:191]
    v_lshrrev_b32 v15, 5, v1
    v_lshlrev_b32 v15, 4, v15
    s_lshl_b32 s41, s48, 7
    s_add_u32 s41, s41, 149504
    v_add_u32 v15, s41, v15
    ds_read_b128 v[16:19], v15 offset:0
    ds_read_b128 v[20:23], v15 offset:32
    ds_read_b128 v[24:27], v15 offset:64
    ds_read_b128 v[28:31], v15 offset:96
    ds_read_b128 v[32:35], v15 offset:256
    ds_read_b128 v[36:39], v15 offset:288
    ds_read_b128 v[40:43], v15 offset:320
    ds_read_b128 v[44:47], v15 offset:352
    v_mov_b32 v14, 150016
    ds_read_b32 v13, v14
    s_lshl_b32 s41, s47, 2
    s_lshl_b32 s50, s39, 3
    s_add_u32 s41, s41, s50
    s_mul_i32 s41, s41, 112
    s_lshl_b32 s50, s40, 2
    s_add_u32 s41, s41, s50
    s_lshl_b32 s50, s48, 1
    s_add_u32 s41, s41, s50
    s_lshl_b32 s56, s41, 10
    s_add_u32 s57, s56, 114688
    s_add_u32 s58, s56, 229376
    s_add_u32 s59, s56, 344064
    s_mov_b32 s46, 1.0
    s_mov_b32 s47, 1.0
    v_lshlrev_b32 v62, 4, v1
    s_waitcnt vmcnt(0) lgkmcnt(0)
    v_readfirstlane_b32 s91, v13
    v_mov_b32 v2, v52
    v_mov_b32 v3, v52
    v_mul_f32 v4, 0xbfb8aa3b, v53
    v_mov_b32 v5, v4
    v_mul_f32 v6, v53, v53
    v_mov_b32 v7, v6
    v_pk_fma_f32 v[64:65], v[16:17], v[2:3], v[64:65]
    v_pk_fma_f32 v[66:67], v[18:19], v[2:3], v[66:67]
    v_pk_fma_f32 v[68:69], v[20:21], v[2:3], v[68:69]
    v_pk_fma_f32 v[70:71], v[22:23], v[2:3], v[70:71]
    v_pk_fma_f32 v[128:129], v[32:33], v[2:3], v[128:129]
    v_pk_fma_f32 v[130:131], v[34:35], v[2:3], v[130:131]
    v_pk_fma_f32 v[132:133], v[36:37], v[2:3], v[132:133]
    v_pk_fma_f32 v[134:135], v[38:39], v[2:3], v[134:135]
    v_pk_mul_f32 v[224:225], v[64:65], v[4:5]
    v_pk_mul_f32 v[226:227], v[66:67], v[4:5]
    v_pk_mul_f32 v[228:229], v[68:69], v[4:5]
    v_pk_mul_f32 v[230:231], v[70:71], v[4:5]
    v_exp_f32 v224, v224
    v_exp_f32 v225, v225
    v_exp_f32 v226, v226
    v_exp_f32 v227, v227
    v_exp_f32 v228, v228
    v_exp_f32 v229, v229
    v_exp_f32 v230, v230
    v_exp_f32 v231, v231
    v_pk_mul_f32 v[64:65], v[64:65], v[128:129]
    v_pk_mul_f32 v[66:67], v[66:67], v[130:131]
    v_pk_mul_f32 v[68:69], v[68:69], v[132:133]
    v_pk_mul_f32 v[70:71], v[70:71], v[134:135]
    v_pk_add_f32 v[224:225], v[224:225], s[46:47]
    v_pk_add_f32 v[226:227], v[226:227], s[46:47]
    v_pk_add_f32 v[228:229], v[228:229], s[46:47]
    v_pk_add_f32 v[230:231], v[230:231], s[46:47]
    v_pk_mul_f32 v[64:65], v[64:65], v[6:7]
    v_pk_mul_f32 v[66:67], v[66:67], v[6:7]
    v_pk_mul_f32 v[68:69], v[68:69], v[6:7]
    v_pk_mul_f32 v[70:71], v[70:71], v[6:7]
    v_rcp_f32 v224, v224
    v_rcp_f32 v225, v225
    v_rcp_f32 v226, v226
    v_rcp_f32 v227, v227
    v_rcp_f32 v228, v228
    v_rcp_f32 v229, v229
    v_rcp_f32 v230, v230
    v_rcp_f32 v231, v231
    v_pk_mul_f32 v[64:65], v[64:65], v[224:225]
    v_pk_mul_f32 v[66:67], v[66:67], v[226:227]
    v_pk_mul_f32 v[68:69], v[68:69], v[228:229]
    v_pk_mul_f32 v[70:71], v[70:71], v[230:231]
    v_cvt_pk_bf16_f32 v192, v64, v65
    v_cvt_pk_bf16_f32 v193, v66, v67
    v_cvt_pk_bf16_f32 v194, v68, v69
    v_cvt_pk_bf16_f32 v195, v70, v71
    s_cmp_eq_u32 s91, 1
    s_cbranch_scc0 A_S_10
    buffer_store_dwordx4 v[192:195], v62, s[20:23], s56 offen offset:0
    s_branch A_S_11
A_S_10:
    buffer_store_dwordx4 v[192:195], v62, s[20:23], s56 offen offset:0 sc1
A_S_11:
    v_pk_fma_f32 v[72:73], v[24:25], v[2:3], v[72:73]
    v_pk_fma_f32 v[74:75], v[26:27], v[2:3], v[74:75]
    v_pk_fma_f32 v[76:77], v[28:29], v[2:3], v[76:77]
    v_pk_fma_f32 v[78:79], v[30:31], v[2:3], v[78:79]
    v_pk_fma_f32 v[136:137], v[40:41], v[2:3], v[136:137]
    v_pk_fma_f32 v[138:139], v[42:43], v[2:3], v[138:139]
    v_pk_fma_f32 v[140:141], v[44:45], v[2:3], v[140:141]
    v_pk_fma_f32 v[142:143], v[46:47], v[2:3], v[142:143]
    v_pk_mul_f32 v[232:233], v[72:73], v[4:5]
    v_pk_mul_f32 v[234:235], v[74:75], v[4:5]
    v_pk_mul_f32 v[236:237], v[76:77], v[4:5]
    v_pk_mul_f32 v[238:239], v[78:79], v[4:5]
    v_exp_f32 v232, v232
    v_exp_f32 v233, v233
    v_exp_f32 v234, v234
    v_exp_f32 v235, v235
    v_exp_f32 v236, v236
    v_exp_f32 v237, v237
    v_exp_f32 v238, v238
    v_exp_f32 v239, v239
    v_pk_mul_f32 v[72:73], v[72:73], v[136:137]
    v_pk_mul_f32 v[74:75], v[74:75], v[138:139]
    v_pk_mul_f32 v[76:77], v[76:77], v[140:141]
    v_pk_mul_f32 v[78:79], v[78:79], v[142:143]
    v_pk_add_f32 v[232:233], v[232:233], s[46:47]
    v_pk_add_f32 v[234:235], v[234:235], s[46:47]
    v_pk_add_f32 v[236:237], v[236:237], s[46:47]
    v_pk_add_f32 v[238:239], v[238:239], s[46:47]
    v_pk_mul_f32 v[72:73], v[72:73], v[6:7]
    v_pk_mul_f32 v[74:75], v[74:75], v[6:7]
    v_pk_mul_f32 v[76:77], v[76:77], v[6:7]
    v_pk_mul_f32 v[78:79], v[78:79], v[6:7]
    v_rcp_f32 v232, v232
    v_rcp_f32 v233, v233
    v_rcp_f32 v234, v234
    v_rcp_f32 v235, v235
    v_rcp_f32 v236, v236
    v_rcp_f32 v237, v237
    v_rcp_f32 v238, v238
    v_rcp_f32 v239, v239
    v_pk_mul_f32 v[72:73], v[72:73], v[232:233]
    v_pk_mul_f32 v[74:75], v[74:75], v[234:235]
    v_pk_mul_f32 v[76:77], v[76:77], v[236:237]
    v_pk_mul_f32 v[78:79], v[78:79], v[238:239]
    v_cvt_pk_bf16_f32 v196, v72, v73
    v_cvt_pk_bf16_f32 v197, v74, v75
    v_cvt_pk_bf16_f32 v198, v76, v77
    v_cvt_pk_bf16_f32 v199, v78, v79
    s_cmp_eq_u32 s91, 1
    s_cbranch_scc0 A_S_12
    buffer_store_dwordx4 v[196:199], v62, s[20:23], s56 offen offset:1024
    s_branch A_S_13
A_S_12:
    buffer_store_dwordx4 v[196:199], v62, s[20:23], s56 offen offset:1024 sc1
A_S_13:
    v_mov_b32 v8, v54
    v_mov_b32 v9, v54
    v_mul_f32 v10, 0xbfb8aa3b, v55
    v_mov_b32 v11, v10
    v_mul_f32 v12, v55, v55
    v_mov_b32 v13, v12
    v_pk_fma_f32 v[80:81], v[16:17], v[8:9], v[80:81]
    v_pk_fma_f32 v[82:83], v[18:19], v[8:9], v[82:83]
    v_pk_fma_f32 v[84:85], v[20:21], v[8:9], v[84:85]
    v_pk_fma_f32 v[86:87], v[22:23], v[8:9], v[86:87]
    v_pk_fma_f32 v[144:145], v[32:33], v[8:9], v[144:145]
    v_pk_fma_f32 v[146:147], v[34:35], v[8:9], v[146:147]
    v_pk_fma_f32 v[148:149], v[36:37], v[8:9], v[148:149]
    v_pk_fma_f32 v[150:151], v[38:39], v[8:9], v[150:151]
    v_pk_mul_f32 v[224:225], v[80:81], v[10:11]
    v_pk_mul_f32 v[226:227], v[82:83], v[10:11]
    v_pk_mul_f32 v[228:229], v[84:85], v[10:11]
    v_pk_mul_f32 v[230:231], v[86:87], v[10:11]
    v_exp_f32 v224, v224
    v_exp_f32 v225, v225
    v_exp_f32 v226, v226
    v_exp_f32 v227, v227
    v_exp_f32 v228, v228
    v_exp_f32 v229, v229
    v_exp_f32 v230, v230
    v_exp_f32 v231, v231
    v_pk_mul_f32 v[80:81], v[80:81], v[144:145]
    v_pk_mul_f32 v[82:83], v[82:83], v[146:147]
    v_pk_mul_f32 v[84:85], v[84:85], v[148:149]
    v_pk_mul_f32 v[86:87], v[86:87], v[150:151]
    v_pk_add_f32 v[224:225], v[224:225], s[46:47]
    v_pk_add_f32 v[226:227], v[226:227], s[46:47]
    v_pk_add_f32 v[228:229], v[228:229], s[46:47]
    v_pk_add_f32 v[230:231], v[230:231], s[46:47]
    v_pk_mul_f32 v[80:81], v[80:81], v[12:13]
    v_pk_mul_f32 v[82:83], v[82:83], v[12:13]
    v_pk_mul_f32 v[84:85], v[84:85], v[12:13]
    v_pk_mul_f32 v[86:87], v[86:87], v[12:13]
    v_rcp_f32 v224, v224
    v_rcp_f32 v225, v225
    v_rcp_f32 v226, v226
    v_rcp_f32 v227, v227
    v_rcp_f32 v228, v228
    v_rcp_f32 v229, v229
    v_rcp_f32 v230, v230
    v_rcp_f32 v231, v231
    v_pk_mul_f32 v[80:81], v[80:81], v[224:225]
    v_pk_mul_f32 v[82:83], v[82:83], v[226:227]
    v_pk_mul_f32 v[84:85], v[84:85], v[228:229]
    v_pk_mul_f32 v[86:87], v[86:87], v[230:231]
    v_cvt_pk_bf16_f32 v200, v80, v81
    v_cvt_pk_bf16_f32 v201, v82, v83
    v_cvt_pk_bf16_f32 v202, v84, v85
    v_cvt_pk_bf16_f32 v203, v86, v87
    s_cmp_eq_u32 s91, 1
    s_cbranch_scc0 A_S_14
    buffer_store_dwordx4 v[200:203], v62, s[20:23], s57 offen offset:0
    s_branch A_S_15
A_S_14:
    buffer_store_dwordx4 v[200:203], v62, s[20:23], s57 offen offset:0 sc1
A_S_15:
    v_pk_fma_f32 v[88:89], v[24:25], v[8:9], v[88:89]
    v_pk_fma_f32 v[90:91], v[26:27], v[8:9], v[90:91]
    v_pk_fma_f32 v[92:93], v[28:29], v[8:9], v[92:93]
    v_pk_fma_f32 v[94:95], v[30:31], v[8:9], v[94:95]
    v_pk_fma_f32 v[152:153], v[40:41], v[8:9], v[152:153]
    v_pk_fma_f32 v[154:155], v[42:43], v[8:9], v[154:155]
    v_pk_fma_f32 v[156:157], v[44:45], v[8:9], v[156:157]
    v_pk_fma_f32 v[158:159], v[46:47], v[8:9], v[158:159]
    v_pk_mul_f32 v[232:233], v[88:89], v[10:11]
    v_pk_mul_f32 v[234:235], v[90:91], v[10:11]
    v_pk_mul_f32 v[236:237], v[92:93], v[10:11]
    v_pk_mul_f32 v[238:239], v[94:95], v[10:11]
    v_exp_f32 v232, v232
    v_exp_f32 v233, v233
    v_exp_f32 v234, v234
    v_exp_f32 v235, v235
    v_exp_f32 v236, v236
    v_exp_f32 v237, v237
    v_exp_f32 v238, v238
    v_exp_f32 v239, v239
    v_pk_mul_f32 v[88:89], v[88:89], v[152:153]
    v_pk_mul_f32 v[90:91], v[90:91], v[154:155]
    v_pk_mul_f32 v[92:93], v[92:93], v[156:157]
    v_pk_mul_f32 v[94:95], v[94:95], v[158:159]
    v_pk_add_f32 v[232:233], v[232:233], s[46:47]
    v_pk_add_f32 v[234:235], v[234:235], s[46:47]
    v_pk_add_f32 v[236:237], v[236:237], s[46:47]
    v_pk_add_f32 v[238:239], v[238:239], s[46:47]
    v_pk_mul_f32 v[88:89], v[88:89], v[12:13]
    v_pk_mul_f32 v[90:91], v[90:91], v[12:13]
    v_pk_mul_f32 v[92:93], v[92:93], v[12:13]
    v_pk_mul_f32 v[94:95], v[94:95], v[12:13]
    v_rcp_f32 v232, v232
    v_rcp_f32 v233, v233
    v_rcp_f32 v234, v234
    v_rcp_f32 v235, v235
    v_rcp_f32 v236, v236
    v_rcp_f32 v237, v237
    v_rcp_f32 v238, v238
    v_rcp_f32 v239, v239
    v_pk_mul_f32 v[88:89], v[88:89], v[232:233]
    v_pk_mul_f32 v[90:91], v[90:91], v[234:235]
    v_pk_mul_f32 v[92:93], v[92:93], v[236:237]
    v_pk_mul_f32 v[94:95], v[94:95], v[238:239]
    v_cvt_pk_bf16_f32 v204, v88, v89
    v_cvt_pk_bf16_f32 v205, v90, v91
    v_cvt_pk_bf16_f32 v206, v92, v93
    v_cvt_pk_bf16_f32 v207, v94, v95
    s_cmp_eq_u32 s91, 1
    s_cbranch_scc0 A_S_16
    buffer_store_dwordx4 v[204:207], v62, s[20:23], s57 offen offset:1024
    s_branch A_S_17
A_S_16:
    buffer_store_dwordx4 v[204:207], v62, s[20:23], s57 offen offset:1024 sc1
A_S_17:
    v_mov_b32 v2, v56
    v_mov_b32 v3, v56
    v_mul_f32 v4, 0xbfb8aa3b, v57
    v_mov_b32 v5, v4
    v_mul_f32 v6, v57, v57
    v_mov_b32 v7, v6
    v_pk_fma_f32 v[96:97], v[16:17], v[2:3], v[96:97]
    v_pk_fma_f32 v[98:99], v[18:19], v[2:3], v[98:99]
    v_pk_fma_f32 v[100:101], v[20:21], v[2:3], v[100:101]
    v_pk_fma_f32 v[102:103], v[22:23], v[2:3], v[102:103]
    v_pk_fma_f32 v[160:161], v[32:33], v[2:3], v[160:161]
    v_pk_fma_f32 v[162:163], v[34:35], v[2:3], v[162:163]
    v_pk_fma_f32 v[164:165], v[36:37], v[2:3], v[164:165]
    v_pk_fma_f32 v[166:167], v[38:39], v[2:3], v[166:167]
    v_pk_mul_f32 v[224:225], v[96:97], v[4:5]
    v_pk_mul_f32 v[226:227], v[98:99], v[4:5]
    v_pk_mul_f32 v[228:229], v[100:101], v[4:5]
    v_pk_mul_f32 v[230:231], v[102:103], v[4:5]
    v_exp_f32 v224, v224
    v_exp_f32 v225, v225
    v_exp_f32 v226, v226
    v_exp_f32 v227, v227
    v_exp_f32 v228, v228
    v_exp_f32 v229, v229
    v_exp_f32 v230, v230
    v_exp_f32 v231, v231
    v_pk_mul_f32 v[96:97], v[96:97], v[160:161]
    v_pk_mul_f32 v[98:99], v[98:99], v[162:163]
    v_pk_mul_f32 v[100:101], v[100:101], v[164:165]
    v_pk_mul_f32 v[102:103], v[102:103], v[166:167]
    v_pk_add_f32 v[224:225], v[224:225], s[46:47]
    v_pk_add_f32 v[226:227], v[226:227], s[46:47]
    v_pk_add_f32 v[228:229], v[228:229], s[46:47]
    v_pk_add_f32 v[230:231], v[230:231], s[46:47]
    v_pk_mul_f32 v[96:97], v[96:97], v[6:7]
    v_pk_mul_f32 v[98:99], v[98:99], v[6:7]
    v_pk_mul_f32 v[100:101], v[100:101], v[6:7]
    v_pk_mul_f32 v[102:103], v[102:103], v[6:7]
    v_rcp_f32 v224, v224
    v_rcp_f32 v225, v225
    v_rcp_f32 v226, v226
    v_rcp_f32 v227, v227
    v_rcp_f32 v228, v228
    v_rcp_f32 v229, v229
    v_rcp_f32 v230, v230
    v_rcp_f32 v231, v231
    v_pk_mul_f32 v[96:97], v[96:97], v[224:225]
    v_pk_mul_f32 v[98:99], v[98:99], v[226:227]
    v_pk_mul_f32 v[100:101], v[100:101], v[228:229]
    v_pk_mul_f32 v[102:103], v[102:103], v[230:231]
    v_cvt_pk_bf16_f32 v208, v96, v97
    v_cvt_pk_bf16_f32 v209, v98, v99
    v_cvt_pk_bf16_f32 v210, v100, v101
    v_cvt_pk_bf16_f32 v211, v102, v103
    s_cmp_eq_u32 s91, 1
    s_cbranch_scc0 A_S_18
    buffer_store_dwordx4 v[208:211], v62, s[20:23], s58 offen offset:0
    s_branch A_S_19
A_S_18:
    buffer_store_dwordx4 v[208:211], v62, s[20:23], s58 offen offset:0 sc1
A_S_19:
    v_pk_fma_f32 v[104:105], v[24:25], v[2:3], v[104:105]
    v_pk_fma_f32 v[106:107], v[26:27], v[2:3], v[106:107]
    v_pk_fma_f32 v[108:109], v[28:29], v[2:3], v[108:109]
    v_pk_fma_f32 v[110:111], v[30:31], v[2:3], v[110:111]
    v_pk_fma_f32 v[168:169], v[40:41], v[2:3], v[168:169]
    v_pk_fma_f32 v[170:171], v[42:43], v[2:3], v[170:171]
    v_pk_fma_f32 v[172:173], v[44:45], v[2:3], v[172:173]
    v_pk_fma_f32 v[174:175], v[46:47], v[2:3], v[174:175]
    v_pk_mul_f32 v[232:233], v[104:105], v[4:5]
    v_pk_mul_f32 v[234:235], v[106:107], v[4:5]
    v_pk_mul_f32 v[236:237], v[108:109], v[4:5]
    v_pk_mul_f32 v[238:239], v[110:111], v[4:5]
    v_exp_f32 v232, v232
    v_exp_f32 v233, v233
    v_exp_f32 v234, v234
    v_exp_f32 v235, v235
    v_exp_f32 v236, v236
    v_exp_f32 v237, v237
    v_exp_f32 v238, v238
    v_exp_f32 v239, v239
    v_pk_mul_f32 v[104:105], v[104:105], v[168:169]
    v_pk_mul_f32 v[106:107], v[106:107], v[170:171]
    v_pk_mul_f32 v[108:109], v[108:109], v[172:173]
    v_pk_mul_f32 v[110:111], v[110:111], v[174:175]
    v_pk_add_f32 v[232:233], v[232:233], s[46:47]
    v_pk_add_f32 v[234:235], v[234:235], s[46:47]
    v_pk_add_f32 v[236:237], v[236:237], s[46:47]
    v_pk_add_f32 v[238:239], v[238:239], s[46:47]
    v_pk_mul_f32 v[104:105], v[104:105], v[6:7]
    v_pk_mul_f32 v[106:107], v[106:107], v[6:7]
    v_pk_mul_f32 v[108:109], v[108:109], v[6:7]
    v_pk_mul_f32 v[110:111], v[110:111], v[6:7]
    v_rcp_f32 v232, v232
    v_rcp_f32 v233, v233
    v_rcp_f32 v234, v234
    v_rcp_f32 v235, v235
    v_rcp_f32 v236, v236
    v_rcp_f32 v237, v237
    v_rcp_f32 v238, v238
    v_rcp_f32 v239, v239
    v_pk_mul_f32 v[104:105], v[104:105], v[232:233]
    v_pk_mul_f32 v[106:107], v[106:107], v[234:235]
    v_pk_mul_f32 v[108:109], v[108:109], v[236:237]
    v_pk_mul_f32 v[110:111], v[110:111], v[238:239]
    v_cvt_pk_bf16_f32 v212, v104, v105
    v_cvt_pk_bf16_f32 v213, v106, v107
    v_cvt_pk_bf16_f32 v214, v108, v109
    v_cvt_pk_bf16_f32 v215, v110, v111
    s_cmp_eq_u32 s91, 1
    s_cbranch_scc0 A_S_20
    buffer_store_dwordx4 v[212:215], v62, s[20:23], s58 offen offset:1024
    s_branch A_S_21
A_S_20:
    buffer_store_dwordx4 v[212:215], v62, s[20:23], s58 offen offset:1024 sc1
A_S_21:
    v_mov_b32 v8, v58
    v_mov_b32 v9, v58
    v_mul_f32 v10, 0xbfb8aa3b, v59
    v_mov_b32 v11, v10
    v_mul_f32 v12, v59, v59
    v_mov_b32 v13, v12
    v_pk_fma_f32 v[112:113], v[16:17], v[8:9], v[112:113]
    v_pk_fma_f32 v[114:115], v[18:19], v[8:9], v[114:115]
    v_pk_fma_f32 v[116:117], v[20:21], v[8:9], v[116:117]
    v_pk_fma_f32 v[118:119], v[22:23], v[8:9], v[118:119]
    v_pk_fma_f32 v[176:177], v[32:33], v[8:9], v[176:177]
    v_pk_fma_f32 v[178:179], v[34:35], v[8:9], v[178:179]
    v_pk_fma_f32 v[180:181], v[36:37], v[8:9], v[180:181]
    v_pk_fma_f32 v[182:183], v[38:39], v[8:9], v[182:183]
    v_pk_mul_f32 v[224:225], v[112:113], v[10:11]
    v_pk_mul_f32 v[226:227], v[114:115], v[10:11]
    v_pk_mul_f32 v[228:229], v[116:117], v[10:11]
    v_pk_mul_f32 v[230:231], v[118:119], v[10:11]
    v_exp_f32 v224, v224
    v_exp_f32 v225, v225
    v_exp_f32 v226, v226
    v_exp_f32 v227, v227
    v_exp_f32 v228, v228
    v_exp_f32 v229, v229
    v_exp_f32 v230, v230
    v_exp_f32 v231, v231
    v_pk_mul_f32 v[112:113], v[112:113], v[176:177]
    v_pk_mul_f32 v[114:115], v[114:115], v[178:179]
    v_pk_mul_f32 v[116:117], v[116:117], v[180:181]
    v_pk_mul_f32 v[118:119], v[118:119], v[182:183]
    v_pk_add_f32 v[224:225], v[224:225], s[46:47]
    v_pk_add_f32 v[226:227], v[226:227], s[46:47]
    v_pk_add_f32 v[228:229], v[228:229], s[46:47]
    v_pk_add_f32 v[230:231], v[230:231], s[46:47]
    v_pk_mul_f32 v[112:113], v[112:113], v[12:13]
    v_pk_mul_f32 v[114:115], v[114:115], v[12:13]
    v_pk_mul_f32 v[116:117], v[116:117], v[12:13]
    v_pk_mul_f32 v[118:119], v[118:119], v[12:13]
    v_rcp_f32 v224, v224
    v_rcp_f32 v225, v225
    v_rcp_f32 v226, v226
    v_rcp_f32 v227, v227
    v_rcp_f32 v228, v228
    v_rcp_f32 v229, v229
    v_rcp_f32 v230, v230
    v_rcp_f32 v231, v231
    v_pk_mul_f32 v[112:113], v[112:113], v[224:225]
    v_pk_mul_f32 v[114:115], v[114:115], v[226:227]
    v_pk_mul_f32 v[116:117], v[116:117], v[228:229]
    v_pk_mul_f32 v[118:119], v[118:119], v[230:231]
    v_cvt_pk_bf16_f32 v216, v112, v113
    v_cvt_pk_bf16_f32 v217, v114, v115
    v_cvt_pk_bf16_f32 v218, v116, v117
    v_cvt_pk_bf16_f32 v219, v118, v119
    s_cmp_eq_u32 s91, 1
    s_cbranch_scc0 A_S_22
    buffer_store_dwordx4 v[216:219], v62, s[20:23], s59 offen offset:0
    s_branch A_S_23
A_S_22:
    buffer_store_dwordx4 v[216:219], v62, s[20:23], s59 offen offset:0 sc1
A_S_23:
    v_pk_fma_f32 v[120:121], v[24:25], v[8:9], v[120:121]
    v_pk_fma_f32 v[122:123], v[26:27], v[8:9], v[122:123]
    v_pk_fma_f32 v[124:125], v[28:29], v[8:9], v[124:125]
    v_pk_fma_f32 v[126:127], v[30:31], v[8:9], v[126:127]
    v_pk_fma_f32 v[184:185], v[40:41], v[8:9], v[184:185]
    v_pk_fma_f32 v[186:187], v[42:43], v[8:9], v[186:187]
    v_pk_fma_f32 v[188:189], v[44:45], v[8:9], v[188:189]
    v_pk_fma_f32 v[190:191], v[46:47], v[8:9], v[190:191]
    v_pk_mul_f32 v[232:233], v[120:121], v[10:11]
    v_pk_mul_f32 v[234:235], v[122:123], v[10:11]
    v_pk_mul_f32 v[236:237], v[124:125], v[10:11]
    v_pk_mul_f32 v[238:239], v[126:127], v[10:11]
    v_exp_f32 v232, v232
    v_exp_f32 v233, v233
    v_exp_f32 v234, v234
    v_exp_f32 v235, v235
    v_exp_f32 v236, v236
    v_exp_f32 v237, v237
    v_exp_f32 v238, v238
    v_exp_f32 v239, v239
    v_pk_mul_f32 v[120:121], v[120:121], v[184:185]
    v_pk_mul_f32 v[122:123], v[122:123], v[186:187]
    v_pk_mul_f32 v[124:125], v[124:125], v[188:189]
    v_pk_mul_f32 v[126:127], v[126:127], v[190:191]
    v_pk_add_f32 v[232:233], v[232:233], s[46:47]
    v_pk_add_f32 v[234:235], v[234:235], s[46:47]
    v_pk_add_f32 v[236:237], v[236:237], s[46:47]
    v_pk_add_f32 v[238:239], v[238:239], s[46:47]
    v_pk_mul_f32 v[120:121], v[120:121], v[12:13]
    v_pk_mul_f32 v[122:123], v[122:123], v[12:13]
    v_pk_mul_f32 v[124:125], v[124:125], v[12:13]
    v_pk_mul_f32 v[126:127], v[126:127], v[12:13]
    v_rcp_f32 v232, v232
    v_rcp_f32 v233, v233
    v_rcp_f32 v234, v234
    v_rcp_f32 v235, v235
    v_rcp_f32 v236, v236
    v_rcp_f32 v237, v237
    v_rcp_f32 v238, v238
    v_rcp_f32 v239, v239
    v_pk_mul_f32 v[120:121], v[120:121], v[232:233]
    v_pk_mul_f32 v[122:123], v[122:123], v[234:235]
    v_pk_mul_f32 v[124:125], v[124:125], v[236:237]
    v_pk_mul_f32 v[126:127], v[126:127], v[238:239]
    v_cvt_pk_bf16_f32 v220, v120, v121
    v_cvt_pk_bf16_f32 v221, v122, v123
    v_cvt_pk_bf16_f32 v222, v124, v125
    v_cvt_pk_bf16_f32 v223, v126, v127
    s_cmp_eq_u32 s91, 1
    s_cbranch_scc0 A_S_24
    buffer_store_dwordx4 v[220:223], v62, s[20:23], s59 offen offset:1024
    s_branch A_S_25
A_S_24:
    buffer_store_dwordx4 v[220:223], v62, s[20:23], s59 offen offset:1024 sc1
A_S_25:
    s_waitcnt vmcnt(0)
    s_setprio 0
    v_mov_b32 v2, 150156
    v_mov_b32 v3, 1
    s_mov_b64 exec, 1
    ds_add_rtn_u32 v4, v2, v3
    s_waitcnt lgkmcnt(0)
    v_readfirstlane_b32 s41, v4
    s_mov_b64 exec, -1
    s_cmp_lg_u32 s41, 3
    s_cbranch_scc1 A_NH_26
    s_lshl_b32 s41, s39, 7
    s_lshl_b32 s46, s40, 2
    s_add_u32 s41, s41, s46
    s_add_u32 s41, s41, 13369344
    v_mov_b32 v4, 0
    s_mov_b64 exec, 1
    s_cmp_eq_u32 s91, 1
    s_cbranch_scc0 A_F_27
    buffer_store_dword v3, v4, s[20:23], s41 offen
    s_branch A_F_28
A_F_27:
    buffer_store_dword v3, v4, s[20:23], s41 offen sc1
A_F_28:
    s_mov_b64 exec, -1
A_NH_26:
    s_branch B_GEMM2
A_LOAD:
    s_nop 15
    s_nop 3
    s_sub_u32 s47, s36, 4
    s_setprio 3
    s_lshl_b32 s43, s39, 18
    s_lshl_b32 s41, s47, 16
    s_add_u32 s43, s43, s41
    s_mul_i32 s42, s47, 57344
    s_lshl_b32 s41, s40, 7
    s_add_u32 s42, s42, s41
    s_lshl_b32 s44, s47, 13
    s_lshl_b32 s45, s47, 11
    s_add_u32 s45, s45, 98304
    v_mov_b32 v56, 150164
A_L0:
    ds_read_b32 v57, v56
    s_waitcnt lgkmcnt(0)
    v_readfirstlane_b32 s41, v57
    s_nop 0
    s_cmp_lt_u32 s41, 4
    s_cbranch_scc1 A_L0
    s_add_u32 s41, s39, 1
    s_and_b32 s41, s41, 7
    s_lshl_b32 s55, s41, 7
    s_add_u32 s55, s55, s43
    s_mul_i32 s41, s41, 229376
    s_add_u32 s41, s41, s42
    s_add_u32 s49, s41, 28672
    s_add_u32 m0, s45, 16384
    s_nop 0
    buffer_load_dwordx4 v4, s[12:15], s41 offen lds
    s_add_u32 m0, s45, 17408
    s_nop 0
    buffer_load_dwordx4 v4, s[12:15], s49 offen lds
    s_add_u32 m0, s45, 24576
    s_nop 0
    buffer_load_dwordx4 v4, s[16:19], s41 offen lds
    s_add_u32 m0, s45, 25600
    s_nop 0
    buffer_load_dwordx4 v4, s[16:19], s49 offen lds
    s_add_u32 m0, s44, 32768
    s_add_u32 s46, s55, 0
    buffer_load_dwordx4 v2, s[8:11], s46 offen lds
    s_add_u32 m0, s44, 33792
    s_add_u32 s46, s55, 8192
    buffer_load_dwordx4 v3, s[8:11], s46 offen lds
    s_add_u32 m0, s44, 34816
    s_add_u32 s46, s55, 16384
    buffer_load_dwordx4 v2, s[8:11], s46 offen lds
    s_add_u32 m0, s44, 35840
    s_add_u32 s46, s55, 24576
    buffer_load_dwordx4 v3, s[8:11], s46 offen lds
    s_add_u32 m0, s44, 36864
    s_add_u32 s46, s55, 32768
    buffer_load_dwordx4 v2, s[8:11], s46 offen lds
    s_add_u32 m0, s44, 37888
    s_add_u32 s46, s55, 40960
    buffer_load_dwordx4 v3, s[8:11], s46 offen lds
    s_add_u32 m0, s44, 38912
    s_add_u32 s46, s55, 49152
    buffer_load_dwordx4 v2, s[8:11], s46 offen lds
    s_add_u32 m0, s44, 39936
    s_add_u32 s46, s55, 57344
    buffer_load_dwordx4 v3, s[8:11], s46 offen lds
    s_lshl_b32 s41, s53, 3
    s_lshl_b32 s46, s47, 1
    s_add_u32 s41, s41, s46
    s_lshl_b32 s41, s41, 10
    s_lshl_b32 s52, s47, 4
    s_add_u32 s52, s52, 148480
    v_lshlrev_b32 v245, 4, v1
    buffer_load_dwordx4 v[220:223], v245, s[8:11], s41 offen
    buffer_load_dwordx4 v[224:227], v245, s[8:11], s41 offen offset:1024
    s_add_u32 s41, s39, 2
    s_and_b32 s41, s41, 7
    s_lshl_b32 s55, s41, 7
    s_add_u32 s55, s55, s43
    s_mul_i32 s41, s41, 229376
    s_add_u32 s41, s41, s42
    s_add_u32 s49, s41, 28672
    s_add_u32 m0, s45, 32768
    s_nop 0
    buffer_load_dwordx4 v4, s[12:15], s41 offen lds
    s_add_u32 m0, s45, 33792
    s_nop 0
    buffer_load_dwordx4 v4, s[12:15], s49 offen lds
    s_add_u32 m0, s45, 40960
    s_nop 0
    buffer_load_dwordx4 v4, s[16:19], s41 offen lds
    s_add_u32 m0, s45, 41984
    s_nop 0
    buffer_load_dwordx4 v4, s[16:19], s49 offen lds
    s_add_u32 m0, s44, 65536
    s_add_u32 s46, s55, 0
    buffer_load_dwordx4 v2, s[8:11], s46 offen lds
    s_add_u32 m0, s44, 66560
    s_add_u32 s46, s55, 8192
    buffer_load_dwordx4 v3, s[8:11], s46 offen lds
    s_add_u32 m0, s44, 67584
    s_add_u32 s46, s55, 16384
    buffer_load_dwordx4 v2, s[8:11], s46 offen lds
    s_add_u32 m0, s44, 68608
    s_add_u32 s46, s55, 24576
    buffer_load_dwordx4 v3, s[8:11], s46 offen lds
    s_add_u32 m0, s44, 69632
    s_add_u32 s46, s55, 32768
    buffer_load_dwordx4 v2, s[8:11], s46 offen lds
    s_add_u32 m0, s44, 70656
    s_add_u32 s46, s55, 40960
    buffer_load_dwordx4 v3, s[8:11], s46 offen lds
    s_add_u32 m0, s44, 71680
    s_add_u32 s46, s55, 49152
    buffer_load_dwordx4 v2, s[8:11], s46 offen lds
    s_add_u32 m0, s44, 72704
    s_add_u32 s46, s55, 57344
    buffer_load_dwordx4 v3, s[8:11], s46 offen lds
    s_mov_b32 s24, s32
    s_mov_b32 s25, s33
    s_mov_b32 s26, 0x100
    s_mov_b32 s27, 0x00020000
    s_waitcnt vmcnt(12) lgkmcnt(0)
    s_barrier
    s_add_u32 s41, s39, 3
    s_and_b32 s41, s41, 7
    s_lshl_b32 s55, s41, 7
    s_add_u32 s55, s55, s43
    s_mul_i32 s41, s41, 229376
    s_add_u32 s41, s41, s42
    s_add_u32 s49, s41, 28672
    s_add_u32 m0, s45, 0
    s_nop 0
    buffer_load_dwordx4 v4, s[12:15], s41 offen lds
    v_lshlrev_b32 v132, 16, v220
    v_and_b32 v133, 0xffff0000, v220
    v_lshlrev_b32 v134, 16, v221
    v_and_b32 v135, 0xffff0000, v221
    v_lshlrev_b32 v136, 16, v222
    v_and_b32 v137, 0xffff0000, v222
    v_lshlrev_b32 v138, 16, v223
    v_and_b32 v139, 0xffff0000, v223
    v_lshlrev_b32 v144, 16, v224
    v_and_b32 v145, 0xffff0000, v224
    v_lshlrev_b32 v146, 16, v225
    s_add_u32 m0, s45, 1024
    s_nop 0
    buffer_load_dwordx4 v4, s[12:15], s49 offen lds
    v_and_b32 v147, 0xffff0000, v225
    v_lshlrev_b32 v148, 16, v226
    v_and_b32 v149, 0xffff0000, v226
    v_lshlrev_b32 v150, 16, v227
    v_and_b32 v151, 0xffff0000, v227
    v_pk_add_f32 v[140:141], v[132:133], v[134:135]
    v_pk_add_f32 v[142:143], v[136:137], v[138:139]
    v_pk_add_f32 v[152:153], v[144:145], v[146:147]
    v_pk_add_f32 v[154:155], v[148:149], v[150:151]
    v_pk_add_f32 v[140:141], v[140:141], v[142:143]
    v_add_f32 v140, v140, v141
    s_add_u32 m0, s45, 8192
    s_nop 0
    buffer_load_dwordx4 v4, s[16:19], s41 offen lds
    v_pk_add_f32 v[152:153], v[152:153], v[154:155]
    v_add_f32 v152, v152, v153
    v_add_f32_dpp v140, v140, v140 quad_perm:[1,0,3,2] row_mask:0xf bank_mask:0xf
    s_nop 0
    v_add_f32_dpp v152, v152, v152 quad_perm:[1,0,3,2] row_mask:0xf bank_mask:0xf
    v_add_f32_dpp v140, v140, v140 quad_perm:[2,3,0,1] row_mask:0xf bank_mask:0xf
    s_nop 0
    v_add_f32_dpp v152, v152, v152 quad_perm:[2,3,0,1] row_mask:0xf bank_mask:0xf
    v_add_f32_dpp v140, v140, v140 row_half_mirror row_mask:0xf bank_mask:0xf
    s_nop 0
    v_add_f32_dpp v152, v152, v152 row_half_mirror row_mask:0xf bank_mask:0xf
    v_add_f32_dpp v140, v140, v140 row_mirror row_mask:0xf bank_mask:0xf
    s_nop 0
    v_add_f32_dpp v152, v152, v152 row_mirror row_mask:0xf bank_mask:0xf
    v_mov_b32 v141, v140
    s_add_u32 m0, s45, 9216
    s_nop 0
    buffer_load_dwordx4 v4, s[16:19], s49 offen lds
    v_mov_b32 v153, v152
    v_permlane16_swap_b32 v140, v141
    s_nop 0
    v_permlane16_swap_b32 v152, v153
    v_add_f32 v140, v140, v141
    v_add_f32 v152, v152, v153
    v_mov_b32 v141, v140
    v_mov_b32 v153, v152
    s_nop 0
    v_permlane32_swap_b32 v140, v141
    v_permlane32_swap_b32 v152, v153
    v_add_f32 v140, v140, v141
    v_add_f32 v152, v152, v153
    s_add_u32 m0, s44, 0
    s_add_u32 s46, s55, 0
    buffer_load_dwordx4 v2, s[8:11], s46 offen lds
    v_mul_f32 v140, 0x3b000000, v140
    v_mul_f32 v152, 0x3b000000, v152
    v_sub_f32 v132, v132, v140
    v_sub_f32 v133, v133, v140
    v_sub_f32 v134, v134, v140
    v_sub_f32 v135, v135, v140
    v_sub_f32 v136, v136, v140
    v_sub_f32 v137, v137, v140
    v_sub_f32 v138, v138, v140
    v_sub_f32 v139, v139, v140
    v_sub_f32 v144, v144, v152
    s_add_u32 m0, s44, 1024
    s_add_u32 s46, s55, 8192
    buffer_load_dwordx4 v3, s[8:11], s46 offen lds
    v_sub_f32 v145, v145, v152
    v_sub_f32 v146, v146, v152
    v_sub_f32 v147, v147, v152
    v_sub_f32 v148, v148, v152
    v_sub_f32 v149, v149, v152
    v_sub_f32 v150, v150, v152
    v_sub_f32 v151, v151, v152
    v_mul_f32 v141, v132, v132
    v_mul_f32 v142, v133, v133
    v_mul_f32 v153, v144, v144
    v_mul_f32 v154, v145, v145
    s_add_u32 m0, s44, 2048
    s_add_u32 s46, s55, 16384
    buffer_load_dwordx4 v2, s[8:11], s46 offen lds
    v_fmac_f32 v141, v134, v134
    v_fmac_f32 v153, v146, v146
    v_fmac_f32 v142, v135, v135
    v_fmac_f32 v154, v147, v147
    v_fmac_f32 v141, v136, v136
    v_fmac_f32 v153, v148, v148
    v_fmac_f32 v142, v137, v137
    v_fmac_f32 v154, v149, v149
    v_fmac_f32 v141, v138, v138
    v_fmac_f32 v153, v150, v150
    v_fmac_f32 v142, v139, v139
    s_add_u32 m0, s44, 3072
    s_add_u32 s46, s55, 24576
    buffer_load_dwordx4 v3, s[8:11], s46 offen lds
    v_fmac_f32 v154, v151, v151
    v_add_f32 v141, v141, v142
    v_add_f32 v153, v153, v154
    s_nop 0
    v_add_f32_dpp v141, v141, v141 quad_perm:[1,0,3,2] row_mask:0xf bank_mask:0xf
    v_add_f32_dpp v153, v153, v153 quad_perm:[1,0,3,2] row_mask:0xf bank_mask:0xf
    s_nop 0
    v_add_f32_dpp v141, v141, v141 quad_perm:[2,3,0,1] row_mask:0xf bank_mask:0xf
    v_add_f32_dpp v153, v153, v153 quad_perm:[2,3,0,1] row_mask:0xf bank_mask:0xf
    s_nop 0
    v_add_f32_dpp v141, v141, v141 row_half_mirror row_mask:0xf bank_mask:0xf
    v_add_f32_dpp v153, v153, v153 row_half_mirror row_mask:0xf bank_mask:0xf
    s_nop 0
    v_add_f32_dpp v141, v141, v141 row_mirror row_mask:0xf bank_mask:0xf
    v_add_f32_dpp v153, v153, v153 row_mirror row_mask:0xf bank_mask:0xf
    s_add_u32 m0, s44, 4096
    s_add_u32 s46, s55, 32768
    buffer_load_dwordx4 v2, s[8:11], s46 offen lds
    v_mov_b32 v142, v141
    v_mov_b32 v154, v153
    s_nop 0
    v_permlane16_swap_b32 v141, v142
    v_permlane16_swap_b32 v153, v154
    v_add_f32 v141, v141, v142
    v_add_f32 v153, v153, v154
    v_mov_b32 v142, v141
    v_mov_b32 v154, v153
    s_nop 0
    v_permlane32_swap_b32 v141, v142
    v_permlane32_swap_b32 v153, v154
    v_add_f32 v141, v141, v142
    s_add_u32 m0, s44, 5120
    s_add_u32 s46, s55, 40960
    buffer_load_dwordx4 v3, s[8:11], s46 offen lds
    v_add_f32 v153, v153, v154
    v_mul_f32 v141, 0x3b000000, v141
    v_mul_f32 v153, 0x3b000000, v153
    v_cvt_pk_bf16_f32 v140, v140, v140
    v_cvt_pk_bf16_f32 v152, v152, v152
    v_cvt_pk_bf16_f32 v141, v141, v141
    v_cvt_pk_bf16_f32 v153, v153, v153
    v_lshlrev_b32 v140, 16, v140
    v_lshlrev_b32 v152, 16, v152
    v_lshlrev_b32 v141, 16, v141
    v_lshlrev_b32 v153, 16, v153
    s_add_u32 m0, s44, 6144
    s_add_u32 s46, s55, 49152
    buffer_load_dwordx4 v2, s[8:11], s46 offen lds
    v_add_f32 v141, 0x3727c5ac, v141
    v_add_f32 v153, 0x3727c5ac, v153
    v_cvt_pk_bf16_f32 v141, v141, v141
    v_cvt_pk_bf16_f32 v153, v153, v153
    v_lshlrev_b32 v141, 16, v141
    v_lshlrev_b32 v153, 16, v153
    v_sqrt_f32 v141, v141
    v_sqrt_f32 v153, v153
    v_cvt_pk_bf16_f32 v141, v141, v141
    v_cvt_pk_bf16_f32 v153, v153, v153
    v_lshlrev_b32 v141, 16, v141
    s_add_u32 m0, s44, 7168
    s_add_u32 s46, s55, 57344
    buffer_load_dwordx4 v3, s[8:11], s46 offen lds
    v_lshlrev_b32 v153, 16, v153
    v_rcp_f32 v141, v141
    v_rcp_f32 v153, v153
    v_sub_f32 v140, 0, v140
    v_sub_f32 v152, 0, v152
    v_mov_b32 v142, v152
    v_mov_b32 v143, v153
    v_mov_b32 v139, s52
    s_mov_b64 exec, 1
    ds_write_b128 v139, v[140:143]
    s_mov_b64 exec, -1
    s_waitcnt vmcnt(12) lgkmcnt(0)
    s_barrier
    v_and_b32 v152, 31, v1
    s_lshl_b32 s41, s47, 5
    v_add_u32 v152, s41, v152
    v_lshlrev_b32 v152, 2, v152
    s_add_u32 s41, s39, 4
    s_and_b32 s41, s41, 7
    s_lshl_b32 s55, s41, 7
    s_add_u32 s55, s55, s43
    s_mul_i32 s41, s41, 229376
    s_add_u32 s41, s41, s42
    s_add_u32 s49, s41, 28672
    s_add_u32 m0, s45, 16384
    s_nop 0
    buffer_load_dwordx4 v4, s[12:15], s41 offen lds
    s_bfe_u32 s92, s36, 0x10001
    s_lshl_b32 s92, s92, 4
    s_lshr_b32 s94, s100, s92
    s_lshl_b32 s94, s94, 16
    s_lshr_b32 s93, s101, s92
    s_lshl_b32 s93, s93, 16
    v_lshlrev_b32 v12, 16, v246
    v_lshlrev_b32 v13, 16, v247
    s_add_u32 m0, s45, 17408
    s_nop 0
    buffer_load_dwordx4 v4, s[12:15], s49 offen lds
    v_lshlrev_b32 v14, 16, v248
    v_lshlrev_b32 v15, 16, v249
    v_lshlrev_b32 v16, 16, v250
    v_lshlrev_b32 v17, 16, v251
    v_mov_b32 v18, 0x3fb8aa3b
    v_mul_f32 v18, s94, v18
    v_exp_f32 v18, v18
    s_nop 0
    v_cvt_pk_bf16_f32 v18, v18, v18
    s_add_u32 m0, s45, 24576
    s_nop 0
    buffer_load_dwordx4 v4, s[16:19], s41 offen lds
    v_lshlrev_b32 v18, 16, v18
    v_mul_f32 v12, v18, v12
    v_mul_f32 v13, v18, v13
    v_mul_f32 v14, v18, v14
    v_mul_f32 v15, v18, v15
    v_mul_f32 v12, 0x3fb8aa3b, v12
    v_mul_f32 v13, 0x3e22f983, v13
    v_mov_b32 v44, v12
    s_add_u32 m0, s45, 25600
    s_nop 0
    buffer_load_dwordx4 v4, s[16:19], s49 offen lds
    v_mov_b32 v45, v13
    v_mul_f32 v46, 0x41000000, v12
    v_mul_f32 v47, 0x41000000, v13
    v_mul_f32 v48, 0x43000000, v12
    v_mul_f32 v49, 0x43000000, v13
    v_fract_f32 v45, v45
    v_fract_f32 v47, v47
    v_fract_f32 v49, v49
    s_add_u32 m0, s44, 32768
    s_add_u32 s46, s55, 0
    buffer_load_dwordx4 v2, s[8:11], s46 offen lds
    v_exp_f32 v44, v44
    v_exp_f32 v46, v46
    v_exp_f32 v48, v48
    v_cos_f32 v20, v45
    v_cos_f32 v34, v47
    v_cos_f32 v36, v49
    v_sin_f32 v21, v45
    v_sin_f32 v35, v47
    s_add_u32 m0, s44, 33792
    s_add_u32 s46, s55, 8192
    buffer_load_dwordx4 v3, s[8:11], s46 offen lds
    v_sin_f32 v37, v49
    v_mul_f32 v20, v20, v44
    v_mul_f32 v21, v21, v44
    v_mul_f32 v34, v34, v46
    v_mul_f32 v35, v35, v46
    v_mul_f32 v36, v36, v48
    v_mul_f32 v37, v37, v48
    v_mov_b32 v64, 1.0
    s_add_u32 m0, s44, 34816
    s_add_u32 s46, s55, 16384
    buffer_load_dwordx4 v2, s[8:11], s46 offen lds
    v_mov_b32 v65, 0
    v_mov_b32 v66, v34
    v_mov_b32 v67, v35
    v_mul_f32 v50, v16, v14
    v_mul_f32 v52, v20, v20
    v_mul_f32 v54, v34, v34
    v_mul_f32 v56, v36, v36
    v_mul_f32 v51, v16, v15
    s_add_u32 m0, s44, 35840
    s_add_u32 s46, s55, 24576
    buffer_load_dwordx4 v3, s[8:11], s46 offen lds
    v_mul_f32 v53, v20, v21
    v_mul_f32 v55, v34, v35
    v_mul_f32 v57, v36, v37
    v_fma_f32 v96, -v17, v15, v50
    v_fma_f32 v22, -v21, v21, v52
    v_fma_f32 v38, -v35, v35, v54
    v_fma_f32 v40, -v37, v37, v56
    v_fma_f32 v97, v17, v14, v51
    s_add_u32 m0, s44, 36864
    s_add_u32 s46, s55, 32768
    buffer_load_dwordx4 v2, s[8:11], s46 offen lds
    v_fma_f32 v23, v21, v20, v53
    v_fma_f32 v39, v35, v34, v55
    v_fma_f32 v41, v37, v36, v57
    v_mul_f32 v50, v96, v36
    v_mul_f32 v52, v22, v20
    v_mul_f32 v54, v22, v22
    v_mul_f32 v56, v64, v38
    v_mul_f32 v58, v66, v38
    s_add_u32 m0, s44, 37888
    s_add_u32 s46, s55, 40960
    buffer_load_dwordx4 v3, s[8:11], s46 offen lds
    v_mul_f32 v51, v96, v37
    v_mul_f32 v53, v22, v21
    v_mul_f32 v55, v22, v23
    v_mul_f32 v57, v64, v39
    v_mul_f32 v59, v66, v39
    v_fma_f32 v98, -v97, v37, v50
    v_fma_f32 v24, -v23, v21, v52
    v_fma_f32 v26, -v23, v23, v54
    s_add_u32 m0, s44, 38912
    s_add_u32 s46, s55, 49152
    buffer_load_dwordx4 v2, s[8:11], s46 offen lds
    v_fma_f32 v68, -v65, v39, v56
    v_fma_f32 v70, -v67, v39, v58
    v_fma_f32 v99, v97, v36, v51
    v_fma_f32 v25, v23, v20, v53
    v_fma_f32 v27, v23, v22, v55
    v_fma_f32 v69, v65, v38, v57
    v_fma_f32 v71, v67, v38, v59
    v_mul_f32 v50, v96, v40
    s_add_u32 m0, s44, 39936
    s_add_u32 s46, s55, 57344
    buffer_load_dwordx4 v3, s[8:11], s46 offen lds
    v_mul_f32 v52, v98, v40
    v_mul_f32 v54, v26, v20
    v_mul_f32 v56, v26, v22
    v_mul_f32 v58, v26, v24
    v_mul_f32 v60, v68, v38
    v_mul_f32 v51, v96, v41
    v_mul_f32 v53, v98, v41
    v_mul_f32 v55, v26, v21
    s_waitcnt vmcnt(12) lgkmcnt(0)
    s_barrier
    s_add_u32 s41, s39, 5
    s_and_b32 s41, s41, 7
    s_lshl_b32 s55, s41, 7
    s_add_u32 s55, s55, s43
    s_mul_i32 s41, s41, 229376
    s_add_u32 s41, s41, s42
    s_add_u32 s49, s41, 28672
    s_add_u32 m0, s45, 32768
    s_nop 0
    buffer_load_dwordx4 v4, s[12:15], s41 offen lds
    v_mul_f32 v57, v26, v23
    v_mul_f32 v59, v26, v25
    v_mul_f32 v61, v68, v39
    v_fma_f32 v100, -v97, v41, v50
    v_fma_f32 v102, -v99, v41, v52
    v_fma_f32 v28, -v27, v21, v54
    v_fma_f32 v30, -v27, v23, v56
    v_fma_f32 v32, -v27, v25, v58
    s_add_u32 m0, s45, 33792
    s_nop 0
    buffer_load_dwordx4 v4, s[12:15], s49 offen lds
    v_fma_f32 v72, -v69, v39, v60
    v_fma_f32 v101, v97, v40, v51
    v_fma_f32 v103, v99, v40, v53
    v_fma_f32 v29, v27, v20, v55
    v_fma_f32 v31, v27, v22, v57
    v_fma_f32 v33, v27, v24, v59
    v_fma_f32 v73, v69, v38, v61
    v_cvt_pk_bf16_f32 v201, v64, v65
    s_add_u32 m0, s45, 40960
    s_nop 0
    buffer_load_dwordx4 v4, s[16:19], s41 offen lds
    v_cvt_pk_bf16_f32 v202, v66, v67
    v_cvt_pk_bf16_f32 v203, v68, v69
    v_cvt_pk_bf16_f32 v204, v70, v71
    v_cvt_pk_bf16_f32 v160, v96, -v97
    v_cvt_pk_bf16_f32 v168, v98, -v99
    v_cvt_pk_bf16_f32 v176, v100, -v101
    v_cvt_pk_bf16_f32 v180, v102, -v103
    v_mul_f32 v50, v100, v40
    s_add_u32 m0, s45, 41984
    s_nop 0
    buffer_load_dwordx4 v4, s[16:19], s49 offen lds
    v_mul_f32 v52, v102, v40
    v_mul_f32 v54, v70, v38
    v_mul_f32 v56, v72, v38
    v_mul_f32 v51, v100, v41
    v_mul_f32 v53, v102, v41
    v_mul_f32 v55, v70, v39
    v_mul_f32 v57, v72, v39
    v_fma_f32 v104, -v101, v41, v50
    s_add_u32 m0, s44, 65536
    s_add_u32 s46, s55, 0
    buffer_load_dwordx4 v2, s[8:11], s46 offen lds
    v_fma_f32 v106, -v103, v41, v52
    v_fma_f32 v74, -v71, v39, v54
    v_fma_f32 v76, -v73, v39, v56
    v_fma_f32 v105, v101, v40, v51
    v_fma_f32 v107, v103, v40, v53
    v_fma_f32 v75, v71, v38, v55
    v_fma_f32 v77, v73, v38, v57
    v_mul_f32 v50, v104, v40
    s_add_u32 m0, s44, 66560
    s_add_u32 s46, s55, 8192
    buffer_load_dwordx4 v3, s[8:11], s46 offen lds
    v_mul_f32 v52, v106, v40
    v_mul_f32 v54, v74, v38
    v_mul_f32 v56, v76, v38
    v_mul_f32 v51, v104, v41
    v_mul_f32 v53, v106, v41
    v_mul_f32 v55, v74, v39
    v_mul_f32 v57, v76, v39
    v_fma_f32 v108, -v105, v41, v50
    s_add_u32 m0, s44, 67584
    s_add_u32 s46, s55, 16384
    buffer_load_dwordx4 v2, s[8:11], s46 offen lds
    v_fma_f32 v110, -v107, v41, v52
    v_fma_f32 v78, -v75, v39, v54
    v_fma_f32 v80, -v77, v39, v56
    v_fma_f32 v109, v105, v40, v51
    v_fma_f32 v111, v107, v40, v53
    v_fma_f32 v79, v75, v38, v55
    v_fma_f32 v81, v77, v38, v57
    v_mul_f32 v50, v108, v40
    s_add_u32 m0, s44, 68608
    s_add_u32 s46, s55, 24576
    buffer_load_dwordx4 v3, s[8:11], s46 offen lds
    v_mul_f32 v52, v110, v40
    v_mul_f32 v54, v78, v38
    v_mul_f32 v56, v80, v38
    v_mul_f32 v51, v108, v41
    v_mul_f32 v53, v110, v41
    v_mul_f32 v55, v78, v39
    v_mul_f32 v57, v80, v39
    v_fma_f32 v112, -v109, v41, v50
    s_add_u32 m0, s44, 69632
    s_add_u32 s46, s55, 32768
    buffer_load_dwordx4 v2, s[8:11], s46 offen lds
    v_fma_f32 v114, -v111, v41, v52
    v_fma_f32 v82, -v79, v39, v54
    v_fma_f32 v84, -v81, v39, v56
    v_fma_f32 v113, v109, v40, v51
    v_fma_f32 v115, v111, v40, v53
    v_fma_f32 v83, v79, v38, v55
    v_fma_f32 v85, v81, v38, v57
    v_mul_f32 v50, v112, v40
    s_add_u32 m0, s44, 70656
    s_add_u32 s46, s55, 40960
    buffer_load_dwordx4 v3, s[8:11], s46 offen lds
    v_mul_f32 v52, v114, v40
    v_mul_f32 v54, v82, v38
    v_mul_f32 v56, v84, v38
    v_mul_f32 v51, v112, v41
    v_mul_f32 v53, v114, v41
    v_mul_f32 v55, v82, v39
    v_mul_f32 v57, v84, v39
    v_fma_f32 v116, -v113, v41, v50
    s_add_u32 m0, s44, 71680
    s_add_u32 s46, s55, 49152
    buffer_load_dwordx4 v2, s[8:11], s46 offen lds
    v_fma_f32 v118, -v115, v41, v52
    v_fma_f32 v86, -v83, v39, v54
    v_fma_f32 v88, -v85, v39, v56
    v_fma_f32 v117, v113, v40, v51
    v_fma_f32 v119, v115, v40, v53
    v_fma_f32 v87, v83, v38, v55
    v_fma_f32 v89, v85, v38, v57
    v_mul_f32 v50, v116, v40
    s_add_u32 m0, s44, 72704
    s_add_u32 s46, s55, 57344
    buffer_load_dwordx4 v3, s[8:11], s46 offen lds
    v_mul_f32 v52, v118, v40
    v_mul_f32 v54, v86, v38
    v_mul_f32 v56, v88, v38
    v_mul_f32 v51, v116, v41
    v_mul_f32 v53, v118, v41
    v_mul_f32 v55, v86, v39
    v_mul_f32 v57, v88, v39
    v_fma_f32 v120, -v117, v41, v50
    s_waitcnt vmcnt(12) lgkmcnt(0)
    s_barrier
    s_add_u32 s41, s39, 6
    s_and_b32 s41, s41, 7
    s_lshl_b32 s55, s41, 7
    s_add_u32 s55, s55, s43
    s_mul_i32 s41, s41, 229376
    s_add_u32 s41, s41, s42
    s_add_u32 s49, s41, 28672
    s_add_u32 m0, s45, 0
    s_nop 0
    buffer_load_dwordx4 v4, s[12:15], s41 offen lds
    v_fma_f32 v122, -v119, v41, v52
    v_fma_f32 v90, -v87, v39, v54
    v_fma_f32 v92, -v89, v39, v56
    v_fma_f32 v121, v117, v40, v51
    v_fma_f32 v123, v119, v40, v53
    v_fma_f32 v91, v87, v38, v55
    v_fma_f32 v93, v89, v38, v57
    v_mul_f32 v50, v120, v40
    s_add_u32 m0, s45, 1024
    s_nop 0
    buffer_load_dwordx4 v4, s[12:15], s49 offen lds
    v_mul_f32 v52, v122, v40
    v_mul_f32 v54, v90, v38
    v_mul_f32 v51, v120, v41
    v_mul_f32 v53, v122, v41
    v_mul_f32 v55, v90, v39
    v_fma_f32 v124, -v121, v41, v50
    v_fma_f32 v126, -v123, v41, v52
    v_fma_f32 v94, -v91, v39, v54
    s_add_u32 m0, s45, 8192
    s_nop 0
    buffer_load_dwordx4 v4, s[16:19], s41 offen lds
    v_fma_f32 v125, v121, v40, v51
    v_fma_f32 v127, v123, v40, v53
    v_fma_f32 v95, v91, v38, v55
    v_mul_f32 v50, v124, v40
    v_mul_f32 v51, v124, v41
    v_fma_f32 v128, -v125, v41, v50
    v_fma_f32 v129, v125, v40, v51
    v_cvt_pk_bf16_f32 v205, v72, v73
    s_add_u32 m0, s45, 9216
    s_nop 0
    buffer_load_dwordx4 v4, s[16:19], s49 offen lds
    v_cvt_pk_bf16_f32 v206, v74, v75
    v_cvt_pk_bf16_f32 v207, v76, v77
    v_cvt_pk_bf16_f32 v208, v78, v79
    v_cvt_pk_bf16_f32 v209, v80, v81
    v_cvt_pk_bf16_f32 v210, v82, v83
    v_cvt_pk_bf16_f32 v211, v84, v85
    v_cvt_pk_bf16_f32 v212, v86, v87
    v_cvt_pk_bf16_f32 v213, v88, v89
    s_add_u32 m0, s44, 0
    s_add_u32 s46, s55, 0
    buffer_load_dwordx4 v2, s[8:11], s46 offen lds
    v_cvt_pk_bf16_f32 v214, v90, v91
    v_cvt_pk_bf16_f32 v215, v92, v93
    v_cvt_pk_bf16_f32 v216, v94, v95
    v_cvt_pk_bf16_f32 v184, v104, -v105
    v_cvt_pk_bf16_f32 v186, v106, -v107
    v_cvt_pk_bf16_f32 v188, v108, -v109
    v_cvt_pk_bf16_f32 v190, v110, -v111
    v_cvt_pk_bf16_f32 v192, v112, -v113
    s_add_u32 m0, s44, 1024
    s_add_u32 s46, s55, 8192
    buffer_load_dwordx4 v3, s[8:11], s46 offen lds
    v_cvt_pk_bf16_f32 v193, v114, -v115
    v_cvt_pk_bf16_f32 v194, v116, -v117
    v_cvt_pk_bf16_f32 v195, v118, -v119
    v_cvt_pk_bf16_f32 v196, v120, -v121
    v_cvt_pk_bf16_f32 v197, v122, -v123
    v_cvt_pk_bf16_f32 v198, v124, -v125
    v_cvt_pk_bf16_f32 v199, v126, -v127
    v_cvt_pk_bf16_f32 v200, v128, -v129
    s_add_u32 m0, s44, 2048
    s_add_u32 s46, s55, 16384
    buffer_load_dwordx4 v2, s[8:11], s46 offen lds
    v_mul_f32 v50, v96, v20
    v_mul_f32 v52, v98, v20
    v_mul_f32 v54, v96, v22
    v_mul_f32 v56, v98, v22
    v_mul_f32 v58, v96, v24
    v_mul_f32 v60, v98, v24
    v_mul_f32 v51, v96, v21
    v_mul_f32 v53, v98, v21
    s_add_u32 m0, s44, 3072
    s_add_u32 s46, s55, 24576
    buffer_load_dwordx4 v3, s[8:11], s46 offen lds
    v_mul_f32 v55, v96, v23
    v_mul_f32 v57, v98, v23
    v_mul_f32 v59, v96, v25
    v_mul_f32 v61, v98, v25
    v_fma_f32 v130, -v97, v21, v50
    v_fma_f32 v132, -v99, v21, v52
    v_fma_f32 v134, -v97, v23, v54
    v_fma_f32 v136, -v99, v23, v56
    s_add_u32 m0, s44, 4096
    s_add_u32 s46, s55, 32768
    buffer_load_dwordx4 v2, s[8:11], s46 offen lds
    v_fma_f32 v138, -v97, v25, v58
    v_fma_f32 v140, -v99, v25, v60
    v_fma_f32 v131, v97, v20, v51
    v_fma_f32 v133, v99, v20, v53
    v_fma_f32 v135, v97, v22, v55
    v_fma_f32 v137, v99, v22, v57
    v_fma_f32 v139, v97, v24, v59
    v_fma_f32 v141, v99, v24, v61
    s_add_u32 m0, s44, 5120
    s_add_u32 s46, s55, 40960
    buffer_load_dwordx4 v3, s[8:11], s46 offen lds
    v_cvt_pk_bf16_f32 v161, v130, -v131
    v_cvt_pk_bf16_f32 v169, v132, -v133
    v_cvt_pk_bf16_f32 v162, v134, -v135
    v_cvt_pk_bf16_f32 v170, v136, -v137
    v_cvt_pk_bf16_f32 v163, v138, -v139
    v_cvt_pk_bf16_f32 v171, v140, -v141
    v_mul_f32 v50, v96, v26
    v_mul_f32 v52, v98, v26
    s_add_u32 m0, s44, 6144
    s_add_u32 s46, s55, 49152
    buffer_load_dwordx4 v2, s[8:11], s46 offen lds
    v_mul_f32 v54, v96, v28
    v_mul_f32 v56, v98, v28
    v_mul_f32 v58, v96, v30
    v_mul_f32 v60, v98, v30
    v_mul_f32 v51, v96, v27
    v_mul_f32 v53, v98, v27
    v_mul_f32 v55, v96, v29
    v_mul_f32 v57, v98, v29
    s_add_u32 m0, s44, 7168
    s_add_u32 s46, s55, 57344
    buffer_load_dwordx4 v3, s[8:11], s46 offen lds
    v_mul_f32 v59, v96, v31
    v_mul_f32 v61, v98, v31
    v_fma_f32 v130, -v97, v27, v50
    v_fma_f32 v132, -v99, v27, v52
    v_fma_f32 v134, -v97, v29, v54
    v_fma_f32 v136, -v99, v29, v56
    v_fma_f32 v138, -v97, v31, v58
    v_fma_f32 v140, -v99, v31, v60
    s_waitcnt vmcnt(12) lgkmcnt(0)
    s_barrier
    v_and_b32 v10, 31, v1
    v_lshlrev_b32 v10, 2, v10
    s_lshl_b32 s41, s39, 7
    s_add_u32 s41, s41, 13371392
    s_lshl_b32 s46, s40, 7
    s_add_u32 s46, s46, 13373440
    v_mov_b32 v158, s41
    v_mov_b32 v159, s46
    v_cmp_gt_u32 vcc, 32, v1
    s_nop 1
    v_cndmask_b32 v158, v159, v158, vcc
    v_add_u32 v10, v10, v158
    v_cmp_lt_u32 vcc, 39, v1
    v_mov_b32 v158, s41
    s_nop 0
    v_cndmask_b32 v10, v10, v158, vcc
    v_mov_b32 v9, 0
    s_cmp_lg_u32 s36, 4
    s_cbranch_scc1 E_29
    buffer_load_dword v9, v10, s[20:23], 0 offen sc1
    s_branch E_30
E_29:
    buffer_load_dword v218, v245, s[8:11], 0 offen
E_30:
    s_add_u32 s41, s39, 7
    s_and_b32 s41, s41, 7
    s_lshl_b32 s55, s41, 7
    s_add_u32 s55, s55, s43
    s_mul_i32 s41, s41, 229376
    s_add_u32 s41, s41, s42
    s_add_u32 s49, s41, 28672
    s_add_u32 m0, s45, 16384
    s_nop 0
    buffer_load_dwordx4 v4, s[12:15], s41 offen lds
    v_fma_f32 v131, v97, v26, v51
    v_fma_f32 v133, v99, v26, v53
    v_fma_f32 v135, v97, v28, v55
    v_fma_f32 v137, v99, v28, v57
    v_fma_f32 v139, v97, v30, v59
    v_fma_f32 v141, v99, v30, v61
    v_cvt_pk_bf16_f32 v164, v130, -v131
    v_cvt_pk_bf16_f32 v172, v132, -v133
    s_add_u32 m0, s45, 17408
    s_nop 0
    buffer_load_dwordx4 v4, s[12:15], s49 offen lds
    v_cvt_pk_bf16_f32 v165, v134, -v135
    v_cvt_pk_bf16_f32 v173, v136, -v137
    v_cvt_pk_bf16_f32 v166, v138, -v139
    v_cvt_pk_bf16_f32 v174, v140, -v141
    v_mul_f32 v50, v96, v32
    v_mul_f32 v52, v98, v32
    v_mul_f32 v54, v100, v22
    v_mul_f32 v56, v102, v22
    s_add_u32 m0, s45, 24576
    s_nop 0
    buffer_load_dwordx4 v4, s[16:19], s41 offen lds
    v_mul_f32 v58, v100, v26
    v_mul_f32 v60, v102, v26
    v_mul_f32 v51, v96, v33
    v_mul_f32 v53, v98, v33
    v_mul_f32 v55, v100, v23
    v_mul_f32 v57, v102, v23
    v_mul_f32 v59, v100, v27
    v_mul_f32 v61, v102, v27
    s_add_u32 m0, s45, 25600
    s_nop 0
    buffer_load_dwordx4 v4, s[16:19], s49 offen lds
    v_fma_f32 v130, -v97, v33, v50
    v_fma_f32 v132, -v99, v33, v52
    v_fma_f32 v134, -v101, v23, v54
    v_fma_f32 v136, -v103, v23, v56
    v_fma_f32 v138, -v101, v27, v58
    v_fma_f32 v140, -v103, v27, v60
    v_fma_f32 v131, v97, v32, v51
    v_fma_f32 v133, v99, v32, v53
    s_add_u32 m0, s44, 32768
    s_add_u32 s46, s55, 0
    buffer_load_dwordx4 v2, s[8:11], s46 offen lds
    v_fma_f32 v135, v101, v22, v55
    v_fma_f32 v137, v103, v22, v57
    v_fma_f32 v139, v101, v26, v59
    v_fma_f32 v141, v103, v26, v61
    v_cvt_pk_bf16_f32 v167, v130, -v131
    v_cvt_pk_bf16_f32 v175, v132, -v133
    v_cvt_pk_bf16_f32 v177, v134, -v135
    v_cvt_pk_bf16_f32 v181, v136, -v137
    s_add_u32 m0, s44, 33792
    s_add_u32 s46, s55, 8192
    buffer_load_dwordx4 v3, s[8:11], s46 offen lds
    v_cvt_pk_bf16_f32 v178, v138, -v139
    v_cvt_pk_bf16_f32 v182, v140, -v141
    v_mul_f32 v50, v100, v30
    v_mul_f32 v52, v102, v30
    v_mul_f32 v54, v104, v26
    v_mul_f32 v56, v106, v26
    v_mul_f32 v58, v108, v26
    v_mul_f32 v60, v110, v26
    s_add_u32 m0, s44, 34816
    s_add_u32 s46, s55, 16384
    buffer_load_dwordx4 v2, s[8:11], s46 offen lds
    v_mul_f32 v51, v100, v31
    v_mul_f32 v53, v102, v31
    v_mul_f32 v55, v104, v27
    v_mul_f32 v57, v106, v27
    v_mul_f32 v59, v108, v27
    v_mul_f32 v61, v110, v27
    v_fma_f32 v130, -v101, v31, v50
    v_fma_f32 v132, -v103, v31, v52
    s_add_u32 m0, s44, 35840
    s_add_u32 s46, s55, 24576
    buffer_load_dwordx4 v3, s[8:11], s46 offen lds
    v_fma_f32 v134, -v105, v27, v54
    v_fma_f32 v136, -v107, v27, v56
    v_fma_f32 v138, -v109, v27, v58
    v_fma_f32 v140, -v111, v27, v60
    v_fma_f32 v131, v101, v30, v51
    v_fma_f32 v133, v103, v30, v53
    v_fma_f32 v135, v105, v26, v55
    v_fma_f32 v137, v107, v26, v57
    s_add_u32 m0, s44, 36864
    s_add_u32 s46, s55, 32768
    buffer_load_dwordx4 v2, s[8:11], s46 offen lds
    v_fma_f32 v139, v109, v26, v59
    v_fma_f32 v141, v111, v26, v61
    v_cvt_pk_bf16_f32 v179, v130, -v131
    v_cvt_pk_bf16_f32 v183, v132, -v133
    v_cvt_pk_bf16_f32 v185, v134, -v135
    v_cvt_pk_bf16_f32 v187, v136, -v137
    v_cvt_pk_bf16_f32 v189, v138, -v139
    v_cvt_pk_bf16_f32 v191, v140, -v141
    s_add_u32 m0, s44, 37888
    s_add_u32 s46, s55, 40960
    buffer_load_dwordx4 v3, s[8:11], s46 offen lds
    s_and_b32 s92, s36, 1
    s_lshl_b32 s92, s92, 10
    v_lshlrev_b32 v44, 4, v1
    v_add_u32 v44, s92, v44
    v_sub_u32 v44, 2047, v44
    v_subrev_u32 v228, 0, v44
    v_subrev_u32 v229, 1, v44
    v_subrev_u32 v230, 2, v44
    s_add_u32 m0, s44, 38912
    s_add_u32 s46, s55, 49152
    buffer_load_dwordx4 v2, s[8:11], s46 offen lds
    v_subrev_u32 v231, 3, v44
    v_subrev_u32 v232, 4, v44
    v_subrev_u32 v233, 5, v44
    v_subrev_u32 v234, 6, v44
    v_subrev_u32 v235, 7, v44
    v_subrev_u32 v236, 8, v44
    v_subrev_u32 v237, 9, v44
    v_subrev_u32 v238, 10, v44
    s_add_u32 m0, s44, 39936
    s_add_u32 s46, s55, 57344
    buffer_load_dwordx4 v3, s[8:11], s46 offen lds
    v_subrev_u32 v239, 11, v44
    v_subrev_u32 v240, 12, v44
    v_subrev_u32 v241, 13, v44
    v_subrev_u32 v242, 14, v44
    v_subrev_u32 v243, 15, v44
    v_subrev_u32 v244, 16, v44
    v_cvt_f32_i32 v46, v228
    v_cvt_f32_i32 v47, v229
    s_waitcnt vmcnt(12)
    s_cmp_lg_u32 s36, 4
    s_cbranch_scc1 W_31
A_POLL:
    v_cmp_eq_u32 vcc, 0, v9
    s_nop 4
    s_cbranch_vccz A_POLL_OK
    s_sleep 8
    buffer_load_dword v9, v10, s[20:23], 0 offen sc1
    s_waitcnt vmcnt(0)
    s_branch A_POLL
A_POLL_OK:
    v_cmp_eq_u32 vcc, s90, v9
    s_nop 4
    s_cmp_eq_u32 vcc_lo, -1
    s_cselect_b32 s41, 1, 2
    s_mov_b32 s41, 2
    v_mov_b32 v157, s41
    v_mov_b32 v158, 150016
    ds_write_b32 v158, v157
W_31:
    s_waitcnt vmcnt(12) lgkmcnt(0)
    s_barrier
    s_lshl_b32 s41, s40, 12
    s_add_u32 s41, s41, 13402112
    buffer_load_dword v144, v152, s[20:23], s41 offen offset:0 sc1
    buffer_load_dword v145, v152, s[20:23], s41 offen offset:512 sc1
    buffer_load_dword v146, v152, s[20:23], s41 offen offset:1024 sc1
    buffer_load_dword v147, v152, s[20:23], s41 offen offset:1536 sc1
    buffer_load_dword v148, v152, s[20:23], s41 offen offset:2048 sc1
    buffer_load_dword v149, v152, s[20:23], s41 offen offset:2560 sc1
    buffer_load_dword v150, v152, s[20:23], s41 offen offset:3072 sc1
    buffer_load_dword v151, v152, s[20:23], s41 offen offset:3584 sc1
    v_and_b32 v7, 31, v1
    v_lshlrev_b32 v7, 2, v7
    s_lshl_b32 s41, s37, 7
    s_add_u32 s41, s41, 13370368
    v_add_u32 v7, s41, v7
    v_mov_b32 v8, 0
    s_cmp_lg_u32 s36, 7
    s_cbranch_scc1 E_32
    buffer_load_dword v8, v7, s[20:23], 0 offen sc1
    s_branch E_33
E_32:
    buffer_load_dword v218, v245, s[8:11], 0 offen
E_33:
    v_cvt_pk_bf16_f32 v46, v46, v47
    v_lshrrev_b32 v47, 16, v46
    v_and_b32 v46, 0xffff, v46
    v_subrev_u32 v46, 17024, v46
    v_subrev_u32 v47, 17024, v47
    v_cmp_gt_i32 vcc, 128, v228
    s_nop 1
    v_cndmask_b32 v228, v46, v228, vcc
    v_cmp_gt_i32 vcc, 128, v229
    s_nop 1
    v_cndmask_b32 v229, v47, v229, vcc
    v_cvt_f32_i32 v48, v230
    v_cvt_f32_i32 v49, v231
    v_cvt_pk_bf16_f32 v48, v48, v49
    v_lshrrev_b32 v49, 16, v48
    v_and_b32 v48, 0xffff, v48
    v_subrev_u32 v48, 17024, v48
    v_subrev_u32 v49, 17024, v49
    v_cmp_gt_i32 vcc, 128, v230
    s_nop 1
    v_cndmask_b32 v230, v48, v230, vcc
    v_cmp_gt_i32 vcc, 128, v231
    s_nop 1
    v_cndmask_b32 v231, v49, v231, vcc
    v_cvt_f32_i32 v50, v232
    v_cvt_f32_i32 v51, v233
    v_cvt_pk_bf16_f32 v50, v50, v51
    v_lshrrev_b32 v51, 16, v50
    v_and_b32 v50, 0xffff, v50
    v_subrev_u32 v50, 17024, v50
    v_subrev_u32 v51, 17024, v51
    v_cmp_gt_i32 vcc, 128, v232
    s_nop 1
    v_cndmask_b32 v232, v50, v232, vcc
    v_cmp_gt_i32 vcc, 128, v233
    s_nop 1
    v_cndmask_b32 v233, v51, v233, vcc
    v_cvt_f32_i32 v52, v234
    v_cvt_f32_i32 v53, v235
    v_cvt_pk_bf16_f32 v52, v52, v53
    v_lshrrev_b32 v53, 16, v52
    v_and_b32 v52, 0xffff, v52
    v_subrev_u32 v52, 17024, v52
    v_subrev_u32 v53, 17024, v53
    v_cmp_gt_i32 vcc, 128, v234
    s_nop 1
    v_cndmask_b32 v234, v52, v234, vcc
    v_cmp_gt_i32 vcc, 128, v235
    s_nop 1
    v_cndmask_b32 v235, v53, v235, vcc
    v_cvt_f32_i32 v46, v236
    v_cvt_f32_i32 v47, v237
    v_cvt_pk_bf16_f32 v46, v46, v47
    v_lshrrev_b32 v47, 16, v46
    v_and_b32 v46, 0xffff, v46
    v_subrev_u32 v46, 17024, v46
    v_subrev_u32 v47, 17024, v47
    v_cmp_gt_i32 vcc, 128, v236
    s_nop 1
    v_cndmask_b32 v236, v46, v236, vcc
    v_cmp_gt_i32 vcc, 128, v237
    s_nop 1
    v_cndmask_b32 v237, v47, v237, vcc
    v_cvt_f32_i32 v48, v238
    v_cvt_f32_i32 v49, v239
    v_cvt_pk_bf16_f32 v48, v48, v49
    v_lshrrev_b32 v49, 16, v48
    v_and_b32 v48, 0xffff, v48
    v_subrev_u32 v48, 17024, v48
    v_subrev_u32 v49, 17024, v49
    v_cmp_gt_i32 vcc, 128, v238
    s_nop 1
    v_cndmask_b32 v238, v48, v238, vcc
    v_cmp_gt_i32 vcc, 128, v239
    s_nop 1
    v_cndmask_b32 v239, v49, v239, vcc
    v_cvt_f32_i32 v50, v240
    v_cvt_f32_i32 v51, v241
    v_cvt_pk_bf16_f32 v50, v50, v51
    v_lshrrev_b32 v51, 16, v50
    v_and_b32 v50, 0xffff, v50
    v_subrev_u32 v50, 17024, v50
    v_subrev_u32 v51, 17024, v51
    v_cmp_gt_i32 vcc, 128, v240
    s_nop 1
    v_cndmask_b32 v240, v50, v240, vcc
    v_cmp_gt_i32 vcc, 128, v241
    s_nop 1
    v_cndmask_b32 v241, v51, v241, vcc
    v_cvt_f32_i32 v52, v242
    v_cvt_f32_i32 v53, v243
    v_cvt_pk_bf16_f32 v52, v52, v53
    v_lshrrev_b32 v53, 16, v52
    v_and_b32 v52, 0xffff, v52
    v_subrev_u32 v52, 17024, v52
    v_subrev_u32 v53, 17024, v53
    v_cmp_gt_i32 vcc, 128, v242
    s_nop 1
    v_cndmask_b32 v242, v52, v242, vcc
    v_cmp_gt_i32 vcc, 128, v243
    s_nop 1
    v_cndmask_b32 v243, v53, v243, vcc
    v_cvt_f32_i32 v46, v244
    v_cvt_f32_i32 v47, v244
    v_cvt_pk_bf16_f32 v46, v46, v47
    v_lshrrev_b32 v47, 16, v46
    v_and_b32 v46, 0xffff, v46
    v_subrev_u32 v46, 17024, v46
    v_subrev_u32 v47, 17024, v47
    v_cmp_gt_i32 vcc, 128, v244
    s_nop 1
    v_cndmask_b32 v244, v46, v244, vcc
    v_cmp_gt_i32 vcc, 0, v244
    v_mov_b32 v46, 641
    s_nop 0
    v_cndmask_b32 v244, v244, v46, vcc
    v_lshlrev_b32 v228, 1, v228
    v_lshlrev_b32 v229, 1, v229
    v_lshlrev_b32 v230, 1, v230
    v_lshlrev_b32 v231, 1, v231
    v_lshlrev_b32 v232, 1, v232
    v_lshlrev_b32 v233, 1, v233
    v_lshlrev_b32 v234, 1, v234
    v_lshlrev_b32 v235, 1, v235
    v_lshlrev_b32 v236, 1, v236
    v_lshlrev_b32 v237, 1, v237
    v_lshlrev_b32 v238, 1, v238
    v_lshlrev_b32 v239, 1, v239
    v_lshlrev_b32 v240, 1, v240
    v_lshlrev_b32 v241, 1, v241
    v_lshlrev_b32 v242, 1, v242
    v_lshlrev_b32 v243, 1, v243
    v_lshlrev_b32 v244, 1, v244
    s_waitcnt vmcnt(1)
    v_add_f32 v144, v144, v145
    v_add_f32 v146, v146, v147
    v_add_f32 v148, v148, v149
    v_add_f32 v150, v150, v151
    v_add_f32 v144, v144, v146
    v_add_f32 v148, v148, v150
    v_add_f32 v144, v144, v148
    v_add_u32 v153, 149504, v152
    ds_write_b32 v153, v144
    s_waitcnt vmcnt(1) lgkmcnt(0)
    s_barrier
    s_branch B_CONV
MK_AUX:
    s_nop 15
    s_nop 3
    s_sub_u32 s39, s38, 28
    s_lshl_b32 s39, s39, 3
    s_add_u32 s39, s39, s37
    s_cmp_ge_u32 s39, 28
    s_cselect_b32 s40, 28, 0
    s_sub_u32 s40, s39, s40
    v_lshlrev_b32 v2, 4, v1
    v_add_u32 v3, 4096, v2
    s_mov_b32 s24, s32
    s_mov_b32 s25, s33
    s_mov_b32 s26, 0x100
    s_mov_b32 s27, 0x00020000
    s_cmp_lg_u32 s39, 31
    s_cbranch_scc1 A_NZ_34
    s_cmp_lg_u32 s36, 0
    s_cbranch_scc1 A_NZ_34
    v_mov_b32 v8, 0
    v_mov_b32 v9, 0
    v_mov_b32 v10, 0
    v_mov_b32 v11, 0
    s_mov_b32 s45, 13369344
    buffer_store_dwordx4 v[8:11], v2, s[20:23], s45 offen offset:0 sc1
    buffer_store_dwordx4 v[8:11], v2, s[20:23], s45 offen offset:1024 sc1
    buffer_store_dwordx4 v[8:11], v2, s[20:23], s45 offen offset:2048 sc1
    buffer_store_dwordx4 v[8:11], v2, s[20:23], s45 offen offset:3072 sc1
    buffer_store_dwordx4 v[8:11], v3, s[20:23], s45 offen offset:0 sc1
    buffer_store_dwordx4 v[8:11], v3, s[20:23], s45 offen offset:1024 sc1
    buffer_store_dwordx4 v[8:11], v3, s[20:23], s45 offen offset:2048 sc1
    buffer_store_dwordx4 v[8:11], v3, s[20:23], s45 offen offset:3072 sc1
    s_waitcnt vmcnt(0)
    v_mov_b32 v12, 1
    s_mov_b64 exec, 1
    buffer_store_dword v12, v8, s[24:27], 0 offen sc1
    s_mov_b64 exec, -1
A_NZ_34:
    s_lshl_b32 s41, s53, 3
    s_add_u32 s41, s41, s36
    s_lshl_b32 s52, s41, 3
    s_add_u32 s52, s52, 13385728
    s_lshl_b32 s41, s41, 10
    buffer_load_dwordx4 v[40:43], v2, s[8:11], s41 offen
    s_lshl_b32 s42, s36, 13
    s_lshl_b32 s41, s39, 16
    s_add_u32 s41, s41, s42
    buffer_load_dwordx4 v[96:99], v2, s[8:11], s41 offen offset:0
    buffer_load_dwordx4 v[100:103], v2, s[8:11], s41 offen offset:1024
    buffer_load_dwordx4 v[104:107], v2, s[8:11], s41 offen offset:2048
    buffer_load_dwordx4 v[108:111], v2, s[8:11], s41 offen offset:3072
    buffer_load_dwordx4 v[112:115], v3, s[8:11], s41 offen offset:0
    buffer_load_dwordx4 v[116:119], v3, s[8:11], s41 offen offset:1024
    buffer_load_dwordx4 v[120:123], v3, s[8:11], s41 offen offset:2048
    buffer_load_dwordx4 v[124:127], v3, s[8:11], s41 offen offset:3072
    s_mov_b32 s24, s6
    s_mov_b32 s25, s7
    s_mov_b32 s26, 0x1c0000
    s_mov_b32 s27, 0x00020000
    s_lshl_b32 s44, s40, 16
    s_add_u32 s44, s44, s42
    buffer_load_dwordx4 v[176:179], v2, s[24:27], s44 offen offset:0
    buffer_load_dwordx4 v[180:183], v2, s[24:27], s44 offen offset:1024
    buffer_load_dwordx4 v[184:187], v2, s[24:27], s44 offen offset:2048
    buffer_load_dwordx4 v[188:191], v2, s[24:27], s44 offen offset:3072
    buffer_load_dwordx4 v[192:195], v3, s[24:27], s44 offen offset:0
    buffer_load_dwordx4 v[196:199], v3, s[24:27], s44 offen offset:1024
    buffer_load_dwordx4 v[200:203], v3, s[24:27], s44 offen offset:2048
    buffer_load_dwordx4 v[204:207], v3, s[24:27], s44 offen offset:3072
    s_mov_b32 s24, s32
    s_mov_b32 s25, s33
    s_mov_b32 s26, 0x100
    s_mov_b32 s27, 0x00020000
    s_cmp_lt_u32 s36, 4
    s_cbranch_scc1 A_NPF_35
    v_lshlrev_b32 v245, 4, v1
    s_bfe_u32 s58, s36, 0x10001
    s_lshl_b32 s59, s2, 1
    s_add_u32 s58, s58, s59
    s_lshl_b32 s58, s58, 12
    s_and_b32 s59, s36, 1
    s_lshl_b32 s59, s59, 11
    s_add_u32 s58, s58, s59
    s_add_u32 s58, s58, 11272192
    v_mov_b32 v156, -1
    v_mov_b32 v157, -1
    v_mov_b32 v158, -1
    v_mov_b32 v159, -1
    buffer_store_dwordx4 v[156:159], v245, s[20:23], s58 offen sc1
    buffer_store_dwordx4 v[156:159], v245, s[20:23], s58 offen offset:1024 sc1
A_NPF_35:
    s_mov_b32 s84, 0xaaaaaaaa
    s_mov_b32 s85, 0xaaaaaaaa
    s_mov_b32 s86, 0xcccccccc
    s_mov_b32 s87, 0xcccccccc
    s_mov_b32 s88, 0xf0f0f0f0
    s_mov_b32 s89, 0xf0f0f0f0
    s_waitcnt vmcnt(16) lgkmcnt(0)
    v_lshlrev_b32 v44, 16, v40
    v_and_b32 v45, 0xffff0000, v40
    v_lshlrev_b32 v46, 16, v41
    v_and_b32 v47, 0xffff0000, v41
    v_lshlrev_b32 v48, 16, v42
    v_and_b32 v49, 0xffff0000, v42
    v_lshlrev_b32 v50, 16, v43
    v_and_b32 v51, 0xffff0000, v43
    v_pk_add_f32 v[52:53], v[44:45], v[46:47]
    v_pk_add_f32 v[54:55], v[48:49], v[50:51]
    v_pk_add_f32 v[52:53], v[52:53], v[54:55]
    v_add_f32 v52, v52, v53
    s_nop 1
    v_add_f32_dpp v52, v52, v52 quad_perm:[1,0,3,2] row_mask:0xf bank_mask:0xf
    s_nop 1
    v_add_f32_dpp v52, v52, v52 quad_perm:[2,3,0,1] row_mask:0xf bank_mask:0xf
    s_nop 1
    v_add_f32_dpp v52, v52, v52 row_half_mirror row_mask:0xf bank_mask:0xf
    s_nop 1
    v_add_f32_dpp v52, v52, v52 row_mirror row_mask:0xf bank_mask:0xf
    v_mov_b32 v53, v52
    s_nop 1
    v_permlane16_swap_b32 v52, v53
    v_add_f32 v52, v52, v53
    v_mov_b32 v53, v52
    s_nop 1
    v_permlane32_swap_b32 v52, v53
    v_add_f32 v52, v52, v53
    v_mul_f32 v52, 0x3b000000, v52
    v_sub_f32 v44, v44, v52
    v_sub_f32 v45, v45, v52
    v_sub_f32 v46, v46, v52
    v_sub_f32 v47, v47, v52
    v_sub_f32 v48, v48, v52
    v_sub_f32 v49, v49, v52
    v_sub_f32 v50, v50, v52
    v_sub_f32 v51, v51, v52
    v_mul_f32 v53, v44, v44
    v_mul_f32 v54, v45, v45
    v_fmac_f32 v53, v46, v46
    v_fmac_f32 v54, v47, v47
    v_fmac_f32 v53, v48, v48
    v_fmac_f32 v54, v49, v49
    v_fmac_f32 v53, v50, v50
    v_fmac_f32 v54, v51, v51
    v_add_f32 v53, v53, v54
    s_nop 1
    v_add_f32_dpp v53, v53, v53 quad_perm:[1,0,3,2] row_mask:0xf bank_mask:0xf
    s_nop 1
    v_add_f32_dpp v53, v53, v53 quad_perm:[2,3,0,1] row_mask:0xf bank_mask:0xf
    s_nop 1
    v_add_f32_dpp v53, v53, v53 row_half_mirror row_mask:0xf bank_mask:0xf
    s_nop 1
    v_add_f32_dpp v53, v53, v53 row_mirror row_mask:0xf bank_mask:0xf
    v_mov_b32 v54, v53
    s_nop 1
    v_permlane16_swap_b32 v53, v54
    v_add_f32 v53, v53, v54
    v_mov_b32 v54, v53
    s_nop 1
    v_permlane32_swap_b32 v53, v54
    v_add_f32 v53, v53, v54
    v_mul_f32 v53, 0x3b000000, v53
    v_cvt_pk_bf16_f32 v52, v52, v52
    v_lshlrev_b32 v52, 16, v52
    v_cvt_pk_bf16_f32 v53, v53, v53
    v_lshlrev_b32 v53, 16, v53
    v_add_f32 v53, 0x3727c5ac, v53
    v_cvt_pk_bf16_f32 v53, v53, v53
    v_lshlrev_b32 v53, 16, v53
    v_sqrt_f32 v53, v53
    s_nop 0
    v_cvt_pk_bf16_f32 v53, v53, v53
    v_lshlrev_b32 v53, 16, v53
    v_rcp_f32 v53, v53
    v_sub_f32 v52, 0, v52
    v_mov_b32 v54, 0
    s_mov_b64 exec, 1
    buffer_store_dwordx2 v[52:53], v54, s[20:23], s52 offen sc1
    s_mov_b64 exec, -1
    s_waitcnt vmcnt(9)
    v_lshlrev_b32 v32, 16, v96
    v_and_b32 v33, 0xffff0000, v96
    v_lshlrev_b32 v34, 16, v97
    v_and_b32 v35, 0xffff0000, v97
    v_lshlrev_b32 v36, 16, v98
    v_and_b32 v37, 0xffff0000, v98
    v_lshlrev_b32 v38, 16, v99
    v_and_b32 v39, 0xffff0000, v99
    v_lshlrev_b32 v40, 16, v100
    v_and_b32 v41, 0xffff0000, v100
    v_lshlrev_b32 v42, 16, v101
    v_and_b32 v43, 0xffff0000, v101
    v_lshlrev_b32 v44, 16, v102
    v_and_b32 v45, 0xffff0000, v102
    v_lshlrev_b32 v46, 16, v103
    v_and_b32 v47, 0xffff0000, v103
    v_lshlrev_b32 v48, 16, v104
    v_and_b32 v49, 0xffff0000, v104
    v_lshlrev_b32 v50, 16, v105
    v_and_b32 v51, 0xffff0000, v105
    v_lshlrev_b32 v52, 16, v106
    v_and_b32 v53, 0xffff0000, v106
    v_lshlrev_b32 v54, 16, v107
    v_and_b32 v55, 0xffff0000, v107
    v_lshlrev_b32 v56, 16, v108
    v_and_b32 v57, 0xffff0000, v108
    v_lshlrev_b32 v58, 16, v109
    v_and_b32 v59, 0xffff0000, v109
    v_lshlrev_b32 v60, 16, v110
    v_and_b32 v61, 0xffff0000, v110
    v_lshlrev_b32 v62, 16, v111
    v_and_b32 v63, 0xffff0000, v111
    v_lshlrev_b32 v64, 16, v112
    v_and_b32 v65, 0xffff0000, v112
    v_lshlrev_b32 v66, 16, v113
    v_and_b32 v67, 0xffff0000, v113
    v_lshlrev_b32 v68, 16, v114
    v_and_b32 v69, 0xffff0000, v114
    v_lshlrev_b32 v70, 16, v115
    v_and_b32 v71, 0xffff0000, v115
    v_lshlrev_b32 v72, 16, v116
    v_and_b32 v73, 0xffff0000, v116
    v_lshlrev_b32 v74, 16, v117
    v_and_b32 v75, 0xffff0000, v117
    v_lshlrev_b32 v76, 16, v118
    v_and_b32 v77, 0xffff0000, v118
    v_lshlrev_b32 v78, 16, v119
    v_and_b32 v79, 0xffff0000, v119
    v_lshlrev_b32 v80, 16, v120
    v_and_b32 v81, 0xffff0000, v120
    v_lshlrev_b32 v82, 16, v121
    v_and_b32 v83, 0xffff0000, v121
    v_lshlrev_b32 v84, 16, v122
    v_and_b32 v85, 0xffff0000, v122
    v_lshlrev_b32 v86, 16, v123
    v_and_b32 v87, 0xffff0000, v123
    v_lshlrev_b32 v88, 16, v124
    v_and_b32 v89, 0xffff0000, v124
    v_lshlrev_b32 v90, 16, v125
    v_and_b32 v91, 0xffff0000, v125
    v_lshlrev_b32 v92, 16, v126
    v_and_b32 v93, 0xffff0000, v126
    v_lshlrev_b32 v94, 16, v127
    v_and_b32 v95, 0xffff0000, v127
    v_pk_add_f32 v[144:145], v[32:33], v[34:35]
    v_pk_mul_f32 v[152:153], v[32:33], v[32:33]
    v_pk_add_f32 v[144:145], v[144:145], v[36:37]
    v_pk_fma_f32 v[152:153], v[34:35], v[34:35], v[152:153]
    v_pk_add_f32 v[144:145], v[144:145], v[38:39]
    v_pk_fma_f32 v[152:153], v[36:37], v[36:37], v[152:153]
    v_add_f32 v128, v144, v145
    v_pk_fma_f32 v[152:153], v[38:39], v[38:39], v[152:153]
    v_add_f32 v136, v152, v153
    v_pk_add_f32 v[146:147], v[40:41], v[42:43]
    v_pk_mul_f32 v[154:155], v[40:41], v[40:41]
    v_pk_add_f32 v[146:147], v[146:147], v[44:45]
    v_pk_fma_f32 v[154:155], v[42:43], v[42:43], v[154:155]
    v_pk_add_f32 v[146:147], v[146:147], v[46:47]
    v_pk_fma_f32 v[154:155], v[44:45], v[44:45], v[154:155]
    v_add_f32 v129, v146, v147
    v_pk_fma_f32 v[154:155], v[46:47], v[46:47], v[154:155]
    v_add_f32 v137, v154, v155
    v_pk_add_f32 v[148:149], v[48:49], v[50:51]
    v_pk_mul_f32 v[156:157], v[48:49], v[48:49]
    v_pk_add_f32 v[148:149], v[148:149], v[52:53]
    v_pk_fma_f32 v[156:157], v[50:51], v[50:51], v[156:157]
    v_pk_add_f32 v[148:149], v[148:149], v[54:55]
    v_pk_fma_f32 v[156:157], v[52:53], v[52:53], v[156:157]
    v_add_f32 v130, v148, v149
    v_pk_fma_f32 v[156:157], v[54:55], v[54:55], v[156:157]
    v_add_f32 v138, v156, v157
    v_pk_add_f32 v[150:151], v[56:57], v[58:59]
    v_pk_mul_f32 v[158:159], v[56:57], v[56:57]
    v_pk_add_f32 v[150:151], v[150:151], v[60:61]
    v_pk_fma_f32 v[158:159], v[58:59], v[58:59], v[158:159]
    v_pk_add_f32 v[150:151], v[150:151], v[62:63]
    v_pk_fma_f32 v[158:159], v[60:61], v[60:61], v[158:159]
    v_add_f32 v131, v150, v151
    v_pk_fma_f32 v[158:159], v[62:63], v[62:63], v[158:159]
    v_add_f32 v139, v158, v159
    v_pk_add_f32 v[144:145], v[64:65], v[66:67]
    v_pk_mul_f32 v[152:153], v[64:65], v[64:65]
    v_pk_add_f32 v[144:145], v[144:145], v[68:69]
    v_pk_fma_f32 v[152:153], v[66:67], v[66:67], v[152:153]
    v_pk_add_f32 v[144:145], v[144:145], v[70:71]
    v_pk_fma_f32 v[152:153], v[68:69], v[68:69], v[152:153]
    v_add_f32 v132, v144, v145
    v_pk_fma_f32 v[152:153], v[70:71], v[70:71], v[152:153]
    v_add_f32 v140, v152, v153
    v_pk_add_f32 v[146:147], v[72:73], v[74:75]
    v_pk_mul_f32 v[154:155], v[72:73], v[72:73]
    v_pk_add_f32 v[146:147], v[146:147], v[76:77]
    v_pk_fma_f32 v[154:155], v[74:75], v[74:75], v[154:155]
    v_pk_add_f32 v[146:147], v[146:147], v[78:79]
    v_pk_fma_f32 v[154:155], v[76:77], v[76:77], v[154:155]
    v_add_f32 v133, v146, v147
    v_pk_fma_f32 v[154:155], v[78:79], v[78:79], v[154:155]
    v_add_f32 v141, v154, v155
    v_pk_add_f32 v[148:149], v[80:81], v[82:83]
    v_pk_mul_f32 v[156:157], v[80:81], v[80:81]
    v_pk_add_f32 v[148:149], v[148:149], v[84:85]
    v_pk_fma_f32 v[156:157], v[82:83], v[82:83], v[156:157]
    v_pk_add_f32 v[148:149], v[148:149], v[86:87]
    v_pk_fma_f32 v[156:157], v[84:85], v[84:85], v[156:157]
    v_add_f32 v134, v148, v149
    v_pk_fma_f32 v[156:157], v[86:87], v[86:87], v[156:157]
    v_add_f32 v142, v156, v157
    v_pk_add_f32 v[150:151], v[88:89], v[90:91]
    v_pk_mul_f32 v[158:159], v[88:89], v[88:89]
    v_pk_add_f32 v[150:151], v[150:151], v[92:93]
    v_pk_fma_f32 v[158:159], v[90:91], v[90:91], v[158:159]
    v_pk_add_f32 v[150:151], v[150:151], v[94:95]
    v_pk_fma_f32 v[158:159], v[92:93], v[92:93], v[158:159]
    v_add_f32 v135, v150, v151
    v_pk_fma_f32 v[158:159], v[94:95], v[94:95], v[158:159]
    v_add_f32 v143, v158, v159
    v_cndmask_b32 v144, v128, v129, s[84:85]
    v_cndmask_b32 v160, v129, v128, s[84:85]
    v_cndmask_b32 v145, v130, v131, s[84:85]
    v_cndmask_b32 v161, v131, v130, s[84:85]
    v_cndmask_b32 v146, v132, v133, s[84:85]
    v_cndmask_b32 v162, v133, v132, s[84:85]
    v_cndmask_b32 v147, v134, v135, s[84:85]
    v_cndmask_b32 v163, v135, v134, s[84:85]
    v_cndmask_b32 v148, v136, v137, s[84:85]
    v_cndmask_b32 v164, v137, v136, s[84:85]
    v_cndmask_b32 v149, v138, v139, s[84:85]
    v_cndmask_b32 v165, v139, v138, s[84:85]
    v_cndmask_b32 v150, v140, v141, s[84:85]
    v_cndmask_b32 v166, v141, v140, s[84:85]
    v_cndmask_b32 v151, v142, v143, s[84:85]
    v_cndmask_b32 v167, v143, v142, s[84:85]
    v_add_f32_dpp v144, v160, v144 quad_perm:[1,0,3,2] row_mask:0xf bank_mask:0xf
    v_add_f32_dpp v145, v161, v145 quad_perm:[1,0,3,2] row_mask:0xf bank_mask:0xf
    v_add_f32_dpp v146, v162, v146 quad_perm:[1,0,3,2] row_mask:0xf bank_mask:0xf
    v_add_f32_dpp v147, v163, v147 quad_perm:[1,0,3,2] row_mask:0xf bank_mask:0xf
    v_add_f32_dpp v148, v164, v148 quad_perm:[1,0,3,2] row_mask:0xf bank_mask:0xf
    v_add_f32_dpp v149, v165, v149 quad_perm:[1,0,3,2] row_mask:0xf bank_mask:0xf
    v_add_f32_dpp v150, v166, v150 quad_perm:[1,0,3,2] row_mask:0xf bank_mask:0xf
    v_add_f32_dpp v151, v167, v151 quad_perm:[1,0,3,2] row_mask:0xf bank_mask:0xf
    v_cndmask_b32 v128, v144, v145, s[86:87]
    v_cndmask_b32 v160, v145, v144, s[86:87]
    v_cndmask_b32 v129, v146, v147, s[86:87]
    v_cndmask_b32 v161, v147, v146, s[86:87]
    v_cndmask_b32 v130, v148, v149, s[86:87]
    v_cndmask_b32 v162, v149, v148, s[86:87]
    v_cndmask_b32 v131, v150, v151, s[86:87]
    v_cndmask_b32 v163, v151, v150, s[86:87]
    v_add_f32_dpp v128, v160, v128 quad_perm:[2,3,0,1] row_mask:0xf bank_mask:0xf
    v_add_f32_dpp v129, v161, v129 quad_perm:[2,3,0,1] row_mask:0xf bank_mask:0xf
    v_add_f32_dpp v130, v162, v130 quad_perm:[2,3,0,1] row_mask:0xf bank_mask:0xf
    v_add_f32_dpp v131, v163, v131 quad_perm:[2,3,0,1] row_mask:0xf bank_mask:0xf
    v_add_f32_dpp v128, v128, v128 row_ror:4 row_mask:0xf bank_mask:0xf
    v_add_f32_dpp v129, v129, v129 row_ror:4 row_mask:0xf bank_mask:0xf
    v_add_f32_dpp v130, v130, v130 row_ror:4 row_mask:0xf bank_mask:0xf
    v_add_f32_dpp v131, v131, v131 row_ror:4 row_mask:0xf bank_mask:0xf
    v_add_f32_dpp v128, v128, v128 row_ror:8 row_mask:0xf bank_mask:0xf
    v_add_f32_dpp v129, v129, v129 row_ror:8 row_mask:0xf bank_mask:0xf
    v_add_f32_dpp v130, v130, v130 row_ror:8 row_mask:0xf bank_mask:0xf
    v_add_f32_dpp v131, v131, v131 row_ror:8 row_mask:0xf bank_mask:0xf
    v_mov_b32 v160, v128
    v_mov_b32 v161, v129
    v_mov_b32 v162, v130
    v_mov_b32 v163, v131
    v_permlane16_swap_b32 v128, v160
    v_permlane16_swap_b32 v129, v161
    v_permlane16_swap_b32 v130, v162
    v_permlane16_swap_b32 v131, v163
    v_add_f32 v128, v128, v160
    v_add_f32 v129, v129, v161
    v_add_f32 v130, v130, v162
    v_add_f32 v131, v131, v163
    v_mov_b32 v160, v128
    v_mov_b32 v161, v129
    v_mov_b32 v162, v130
    v_mov_b32 v163, v131
    v_permlane32_swap_b32 v128, v160
    v_permlane32_swap_b32 v129, v161
    v_permlane32_swap_b32 v130, v162
    v_permlane32_swap_b32 v131, v163
    v_add_f32 v128, v128, v160
    v_add_f32 v129, v129, v161
    v_add_f32 v130, v130, v162
    v_add_f32 v131, v131, v163
    v_cndmask_b32 v8, v128, v129, s[88:89]
    v_cndmask_b32 v9, v130, v131, s[88:89]
    v_mul_f32 v8, 0x3b000000, v8
    v_mul_f32 v9, 0x3b000000, v9
    v_fma_f32 v9, -v8, v8, v9
    v_max_f32 v9, 0, v9
    v_cvt_pk_bf16_f32 v8, v8, v8
    v_lshlrev_b32 v8, 16, v8
    v_cvt_pk_bf16_f32 v9, v9, v9
    v_lshlrev_b32 v9, 16, v9
    v_add_f32 v9, 0x3727c5ac, v9
    v_cvt_pk_bf16_f32 v9, v9, v9
    v_lshlrev_b32 v9, 16, v9
    v_sqrt_f32 v9, v9
    s_nop 0
    v_cvt_pk_bf16_f32 v9, v9, v9
    v_lshlrev_b32 v9, 16, v9
    v_rcp_f32 v9, v9
    v_sub_f32 v8, 0, v8
    v_mul_f32 v11, v8, v9
    v_readlane_b32 s92, v9, 0
    v_readlane_b32 s93, v9, 0
    v_readlane_b32 s94, v9, 1
    v_readlane_b32 s95, v9, 1
    v_readlane_b32 s56, v9, 2
    v_readlane_b32 s57, v9, 2
    v_readlane_b32 s58, v9, 3
    v_readlane_b32 s59, v9, 3
    v_readlane_b32 s80, v9, 4
    v_readlane_b32 s81, v9, 4
    v_readlane_b32 s82, v9, 5
    v_readlane_b32 s83, v9, 5
    v_readlane_b32 s84, v9, 6
    v_readlane_b32 s85, v9, 6
    v_readlane_b32 s86, v9, 7
    v_readlane_b32 s87, v9, 7
    v_readlane_b32 s46, v11, 0
    s_nop 1
    v_mov_b32 v224, s46
    v_mov_b32 v225, s46
    v_readlane_b32 s47, v11, 1
    s_nop 1
    v_mov_b32 v226, s47
    v_mov_b32 v227, s47
    v_readlane_b32 s46, v11, 2
    s_nop 1
    v_mov_b32 v228, s46
    v_mov_b32 v229, s46
    v_readlane_b32 s47, v11, 3
    s_nop 1
    v_mov_b32 v230, s47
    v_mov_b32 v231, s47
    v_readlane_b32 s46, v11, 4
    s_nop 1
    v_mov_b32 v232, s46
    v_mov_b32 v233, s46
    v_readlane_b32 s47, v11, 5
    s_nop 1
    v_mov_b32 v234, s47
    v_mov_b32 v235, s47
    v_readlane_b32 s46, v11, 6
    s_nop 1
    v_mov_b32 v236, s46
    v_mov_b32 v237, s46
    v_readlane_b32 s47, v11, 7
    s_nop 1
    v_mov_b32 v238, s47
    v_mov_b32 v239, s47
    v_pk_fma_f32 v[32:33], v[32:33], s[92:93], v[224:225]
    v_pk_fma_f32 v[34:35], v[34:35], s[92:93], v[224:225]
    v_pk_fma_f32 v[36:37], v[36:37], s[92:93], v[224:225]
    v_pk_fma_f32 v[38:39], v[38:39], s[92:93], v[224:225]
    v_pk_fma_f32 v[40:41], v[40:41], s[94:95], v[226:227]
    v_pk_fma_f32 v[42:43], v[42:43], s[94:95], v[226:227]
    v_pk_fma_f32 v[44:45], v[44:45], s[94:95], v[226:227]
    v_pk_fma_f32 v[46:47], v[46:47], s[94:95], v[226:227]
    v_pk_fma_f32 v[48:49], v[48:49], s[56:57], v[228:229]
    v_pk_fma_f32 v[50:51], v[50:51], s[56:57], v[228:229]
    v_pk_fma_f32 v[52:53], v[52:53], s[56:57], v[228:229]
    v_pk_fma_f32 v[54:55], v[54:55], s[56:57], v[228:229]
    v_pk_fma_f32 v[56:57], v[56:57], s[58:59], v[230:231]
    v_pk_fma_f32 v[58:59], v[58:59], s[58:59], v[230:231]
    v_pk_fma_f32 v[60:61], v[60:61], s[58:59], v[230:231]
    v_pk_fma_f32 v[62:63], v[62:63], s[58:59], v[230:231]
    v_pk_fma_f32 v[64:65], v[64:65], s[80:81], v[232:233]
    v_pk_fma_f32 v[66:67], v[66:67], s[80:81], v[232:233]
    v_pk_fma_f32 v[68:69], v[68:69], s[80:81], v[232:233]
    v_pk_fma_f32 v[70:71], v[70:71], s[80:81], v[232:233]
    v_pk_fma_f32 v[72:73], v[72:73], s[82:83], v[234:235]
    v_pk_fma_f32 v[74:75], v[74:75], s[82:83], v[234:235]
    v_pk_fma_f32 v[76:77], v[76:77], s[82:83], v[234:235]
    v_pk_fma_f32 v[78:79], v[78:79], s[82:83], v[234:235]
    v_pk_fma_f32 v[80:81], v[80:81], s[84:85], v[236:237]
    v_pk_fma_f32 v[82:83], v[82:83], s[84:85], v[236:237]
    v_pk_fma_f32 v[84:85], v[84:85], s[84:85], v[236:237]
    v_pk_fma_f32 v[86:87], v[86:87], s[84:85], v[236:237]
    v_pk_fma_f32 v[88:89], v[88:89], s[86:87], v[238:239]
    v_pk_fma_f32 v[90:91], v[90:91], s[86:87], v[238:239]
    v_pk_fma_f32 v[92:93], v[92:93], s[86:87], v[238:239]
    v_pk_fma_f32 v[94:95], v[94:95], s[86:87], v[238:239]
    s_add_u32 s45, s42, 65536
    v_xor_b32 v4, 0, v1
    v_lshlrev_b32 v4, 4, v4
    v_add_u32 v4, s45, v4
    v_xor_b32 v5, 4, v1
    v_lshlrev_b32 v5, 4, v5
    v_add_u32 v5, s45, v5
    v_xor_b32 v6, 8, v1
    v_lshlrev_b32 v6, 4, v6
    v_add_u32 v6, s45, v6
    v_xor_b32 v7, 12, v1
    v_lshlrev_b32 v7, 4, v7
    v_add_u32 v7, s45, v7
    s_waitcnt vmcnt(0)
    ds_write_b128 v4, v[176:179] offset:0
    ds_write_b128 v5, v[180:183] offset:1024
    ds_write_b128 v6, v[184:187] offset:2048
    ds_write_b128 v7, v[188:191] offset:3072
    ds_write_b128 v4, v[192:195] offset:4096
    ds_write_b128 v5, v[196:199] offset:5120
    ds_write_b128 v6, v[200:203] offset:6144
    ds_write_b128 v7, v[204:207] offset:7168
    v_cvt_pk_bf16_f32 v128, v32, v33
    v_cvt_pk_bf16_f32 v129, v34, v35
    v_cvt_pk_bf16_f32 v130, v36, v37
    v_cvt_pk_bf16_f32 v131, v38, v39
    v_cvt_pk_bf16_f32 v132, v40, v41
    v_cvt_pk_bf16_f32 v133, v42, v43
    v_cvt_pk_bf16_f32 v134, v44, v45
    v_cvt_pk_bf16_f32 v135, v46, v47
    v_cvt_pk_bf16_f32 v136, v48, v49
    v_cvt_pk_bf16_f32 v137, v50, v51
    v_cvt_pk_bf16_f32 v138, v52, v53
    v_cvt_pk_bf16_f32 v139, v54, v55
    v_cvt_pk_bf16_f32 v140, v56, v57
    v_cvt_pk_bf16_f32 v141, v58, v59
    v_cvt_pk_bf16_f32 v142, v60, v61
    v_cvt_pk_bf16_f32 v143, v62, v63
    v_cvt_pk_bf16_f32 v144, v64, v65
    v_cvt_pk_bf16_f32 v145, v66, v67
    v_cvt_pk_bf16_f32 v146, v68, v69
    v_cvt_pk_bf16_f32 v147, v70, v71
    v_cvt_pk_bf16_f32 v148, v72, v73
    v_cvt_pk_bf16_f32 v149, v74, v75
    v_cvt_pk_bf16_f32 v150, v76, v77
    v_cvt_pk_bf16_f32 v151, v78, v79
    v_cvt_pk_bf16_f32 v152, v80, v81
    v_cvt_pk_bf16_f32 v153, v82, v83
    v_cvt_pk_bf16_f32 v154, v84, v85
    v_cvt_pk_bf16_f32 v155, v86, v87
    v_cvt_pk_bf16_f32 v156, v88, v89
    v_cvt_pk_bf16_f32 v157, v90, v91
    v_cvt_pk_bf16_f32 v158, v92, v93
    v_cvt_pk_bf16_f32 v159, v94, v95
    s_mov_b32 s46, 0x05040100
    s_mov_b32 s47, 0x07060302
    v_perm_b32 v64, v132, v128, s46
    v_perm_b32 v65, v140, v136, s46
    v_perm_b32 v66, v148, v144, s46
    v_perm_b32 v67, v156, v152, s46
    v_perm_b32 v68, v132, v128, s47
    v_perm_b32 v69, v140, v136, s47
    v_perm_b32 v70, v148, v144, s47
    v_perm_b32 v71, v156, v152, s47
    v_perm_b32 v72, v133, v129, s46
    v_perm_b32 v73, v141, v137, s46
    v_perm_b32 v74, v149, v145, s46
    v_perm_b32 v75, v157, v153, s46
    v_perm_b32 v76, v133, v129, s47
    v_perm_b32 v77, v141, v137, s47
    v_perm_b32 v78, v149, v145, s47
    v_perm_b32 v79, v157, v153, s47
    v_perm_b32 v80, v134, v130, s46
    v_perm_b32 v81, v142, v138, s46
    v_perm_b32 v82, v150, v146, s46
    v_perm_b32 v83, v158, v154, s46
    v_perm_b32 v84, v134, v130, s47
    v_perm_b32 v85, v142, v138, s47
    v_perm_b32 v86, v150, v146, s47
    v_perm_b32 v87, v158, v154, s47
    v_perm_b32 v88, v135, v131, s46
    v_perm_b32 v89, v143, v139, s46
    v_perm_b32 v90, v151, v147, s46
    v_perm_b32 v91, v159, v155, s46
    v_perm_b32 v92, v135, v131, s47
    v_perm_b32 v93, v143, v139, s47
    v_perm_b32 v94, v151, v147, s47
    v_perm_b32 v95, v159, v155, s47
    v_and_b32 v16, 7, v1
    v_xor_b32 v16, s36, v16
    v_lshlrev_b32 v16, 4, v16
    v_lshl_add_u32 v16, v1, 10, v16
    ds_write_b128 v16, v[64:67] offset:0
    ds_write_b128 v16, v[68:71] offset:128
    ds_write_b128 v16, v[72:75] offset:256
    ds_write_b128 v16, v[76:79] offset:384
    ds_write_b128 v16, v[80:83] offset:512
    ds_write_b128 v16, v[84:87] offset:640
    ds_write_b128 v16, v[88:91] offset:768
    ds_write_b128 v16, v[92:95] offset:896
    s_waitcnt vmcnt(0) lgkmcnt(0)
    s_barrier
    s_cmp_lg_u32 s36, 0
    s_cbranch_scc1 W0_36
    v_mov_b32 v158, 0
    buffer_load_dword v9, v158, s[24:27], 0 offen sc1
    s_waitcnt vmcnt(0)
X_INIT:
    v_readfirstlane_b32 s41, v9
    s_nop 0
    s_cmp_lg_u32 s41, 0
    s_cbranch_scc1 X_INIT_OK
    s_sleep 8
    v_mov_b32 v158, 0
    buffer_load_dword v9, v158, s[24:27], 0 offen sc1
    s_waitcnt vmcnt(0)
    s_branch X_INIT
X_INIT_OK:
    s_lshl_b32 s41, s37, 7
    s_lshl_b32 s46, s38, 2
    s_add_u32 s41, s41, s46
    s_add_u32 s41, s41, 13371392
    v_mov_b32 v219, s41
    s_lshr_b32 s41, s2, 5
    s_lshl_b32 s41, s41, 7
    s_and_b32 s46, s2, 31
    s_lshl_b32 s46, s46, 2
    s_add_u32 s41, s41, s46
    s_add_u32 s41, s41, 13372416
    v_mov_b32 v154, s41
    v_cmp_eq_u32 vcc, 2, v1
    s_nop 1
    v_cndmask_b32 v219, v219, v154, vcc
    v_mov_b32 v154, s90
    s_mov_b64 exec, 7
    buffer_store_dword v154, v219, s[20:23], 0 offen sc1
    s_mov_b64 exec, -1
W0_36:
    v_lshrrev_b32 v16, 3, v1
    v_and_b32 v17, 7, v1
    v_lshlrev_b32 v18, 12, v16
    v_lshl_add_u32 v18, v17, 4, v18
    v_lshlrev_b32 v19, 7, v16
    s_lshl_b32 s45, s36, 13
    v_add_u32 v19, s45, v19
    v_xor_b32 v20, 0, v17
    v_lshl_add_u32 v20, v20, 4, v19
    ds_read_b128 v[32:35], v20 offset:0
    v_xor_b32 v20, 1, v17
    v_lshl_add_u32 v20, v20, 4, v19
    ds_read_b128 v[36:39], v20 offset:1024
    v_xor_b32 v20, 2, v17
    v_lshl_add_u32 v20, v20, 4, v19
    ds_read_b128 v[40:43], v20 offset:2048
    v_xor_b32 v20, 3, v17
    v_lshl_add_u32 v20, v20, 4, v19
    ds_read_b128 v[44:47], v20 offset:3072
    v_xor_b32 v20, 4, v17
    v_lshl_add_u32 v20, v20, 4, v19
    ds_read_b128 v[48:51], v20 offset:4096
    v_xor_b32 v20, 5, v17
    v_lshl_add_u32 v20, v20, 4, v19
    ds_read_b128 v[52:55], v20 offset:5120
    v_xor_b32 v20, 6, v17
    v_lshl_add_u32 v20, v20, 4, v19
    ds_read_b128 v[56:59], v20 offset:6144
    v_xor_b32 v20, 7, v17
    v_lshl_add_u32 v20, v20, 4, v19
    ds_read_b128 v[60:63], v20 offset:7168
    s_lshl_b32 s45, s36, 18
    s_lshl_b32 s46, s39, 7
    s_add_u32 s45, s45, s46
    s_add_u32 s45, s45, 9175040
    v_lshrrev_b32 v24, 5, v1
    v_bfe_u32 v25, v1, 4, 1
    v_bfe_u32 v26, v1, 2, 2
    v_bfe_u32 v27, v1, 1, 1
    v_and_b32 v28, 1, v1
    s_and_b32 s43, s36, 3
    v_xor_b32 v21, s43, v26
    v_lshlrev_b32 v21, 2, v21
    v_lshl_add_u32 v21, v25, 1, v21
    v_add_u32 v21, v21, v27
    v_lshlrev_b32 v21, 4, v21
    v_lshl_add_u32 v21, v28, 3, v21
    v_lshl_add_u32 v22, v24, 2, v26
    v_lshl_add_u32 v21, v22, 10, v21
    s_and_b32 s43, s36, 4
    s_lshl_b32 s43, s43, 6
    s_add_u32 s43, s43, 65536
    v_add_u32 v21, s43, v21
    ds_read_b64_tr_b16 v[64:65], v21 offset:0
    ds_read_b64_tr_b16 v[66:67], v21 offset:8192
    ds_read_b64_tr_b16 v[68:69], v21 offset:16384
    ds_read_b64_tr_b16 v[70:71], v21 offset:24576
    ds_read_b64_tr_b16 v[72:73], v21 offset:32768
    ds_read_b64_tr_b16 v[74:75], v21 offset:40960
    ds_read_b64_tr_b16 v[76:77], v21 offset:49152
    ds_read_b64_tr_b16 v[78:79], v21 offset:57344
    ds_read_b64_tr_b16 v[80:81], v21 offset:512
    ds_read_b64_tr_b16 v[82:83], v21 offset:8704
    ds_read_b64_tr_b16 v[84:85], v21 offset:16896
    ds_read_b64_tr_b16 v[86:87], v21 offset:25088
    ds_read_b64_tr_b16 v[88:89], v21 offset:33280
    ds_read_b64_tr_b16 v[90:91], v21 offset:41472
    ds_read_b64_tr_b16 v[92:93], v21 offset:49664
    ds_read_b64_tr_b16 v[94:95], v21 offset:57856
    s_waitcnt lgkmcnt(0)
    s_add_u32 s46, s45, 0
    buffer_store_dwordx4 v[32:35], v18, s[20:23], s46 offen sc1
    s_add_u32 s46, s45, 32768
    buffer_store_dwordx4 v[36:39], v18, s[20:23], s46 offen sc1
    s_add_u32 s46, s45, 65536
    buffer_store_dwordx4 v[40:43], v18, s[20:23], s46 offen sc1
    s_add_u32 s46, s45, 98304
    buffer_store_dwordx4 v[44:47], v18, s[20:23], s46 offen sc1
    s_add_u32 s46, s45, 131072
    buffer_store_dwordx4 v[48:51], v18, s[20:23], s46 offen sc1
    s_add_u32 s46, s45, 163840
    buffer_store_dwordx4 v[52:55], v18, s[20:23], s46 offen sc1
    s_add_u32 s46, s45, 196608
    buffer_store_dwordx4 v[56:59], v18, s[20:23], s46 offen sc1
    s_add_u32 s46, s45, 229376
    buffer_store_dwordx4 v[60:63], v18, s[20:23], s46 offen sc1
    s_cmp_ge_u32 s39, 28
    s_cbranch_scc1 A_NOWD_37
    s_mul_i32 s44, s36, 112
    s_lshl_b32 s45, s39, 2
    s_add_u32 s44, s44, s45
    s_lshl_b32 s44, s44, 10
    s_add_u32 s44, s44, 7340032
    buffer_store_dwordx4 v[64:67], v2, s[20:23], s44 offen offset:0 sc1
    buffer_store_dwordx4 v[68:71], v2, s[20:23], s44 offen offset:1024 sc1
    buffer_store_dwordx4 v[72:75], v2, s[20:23], s44 offen offset:2048 sc1
    buffer_store_dwordx4 v[76:79], v2, s[20:23], s44 offen offset:3072 sc1
    s_add_u32 s44, s44, 917504
    buffer_store_dwordx4 v[80:83], v2, s[20:23], s44 offen offset:0 sc1
    buffer_store_dwordx4 v[84:87], v2, s[20:23], s44 offen offset:1024 sc1
    buffer_store_dwordx4 v[88:91], v2, s[20:23], s44 offen offset:2048 sc1
    buffer_store_dwordx4 v[92:95], v2, s[20:23], s44 offen offset:3072 sc1
A_NOWD_37:
    s_waitcnt vmcnt(0)
    s_barrier
    s_lshl_b32 s41, s39, 2
    s_add_u32 s41, s41, 13370368
    s_cmp_lg_u32 s36, 0
    s_cbranch_scc1 W0_38
    v_mov_b32 v154, 1
    v_lshlrev_b32 v219, 7, v1
    s_mov_b64 exec, 0xff
    buffer_store_dword v154, v219, s[20:23], s41 offen sc1
    s_mov_b64 exec, -1
W0_38:
    s_cmp_lt_u32 s36, 4
    s_cbranch_scc1 B_GEMM2
    s_bfe_u32 s92, s36, 0x10001
    s_lshl_b32 s92, s92, 4
    s_lshr_b32 s94, s100, s92
    s_lshl_b32 s94, s94, 16
    s_lshr_b32 s93, s101, s92
    s_lshl_b32 s93, s93, 16
    v_lshlrev_b32 v12, 16, v246
    v_lshlrev_b32 v13, 16, v247
    v_lshlrev_b32 v14, 16, v248
    v_lshlrev_b32 v15, 16, v249
    v_lshlrev_b32 v16, 16, v250
    v_lshlrev_b32 v17, 16, v251
    v_mov_b32 v18, 0x3fb8aa3b
    v_mul_f32 v18, s94, v18
    v_exp_f32 v18, v18
    s_nop 0
    v_cvt_pk_bf16_f32 v18, v18, v18
    v_lshlrev_b32 v18, 16, v18
    v_mul_f32 v12, v18, v12
    v_mul_f32 v13, v18, v13
    v_mul_f32 v14, v18, v14
    v_mul_f32 v15, v18, v15
    v_mul_f32 v12, 0x3fb8aa3b, v12
    v_mul_f32 v13, 0x3e22f983, v13
    v_mov_b32 v44, v12
    v_mov_b32 v45, v13
    v_mul_f32 v46, 0x41000000, v12
    v_mul_f32 v47, 0x41000000, v13
    v_mul_f32 v48, 0x43000000, v12
    v_mul_f32 v49, 0x43000000, v13
    v_fract_f32 v45, v45
    v_fract_f32 v47, v47
    v_fract_f32 v49, v49
    v_exp_f32 v44, v44
    v_exp_f32 v46, v46
    v_exp_f32 v48, v48
    v_cos_f32 v20, v45
    v_cos_f32 v34, v47
    v_cos_f32 v36, v49
    v_sin_f32 v21, v45
    v_sin_f32 v35, v47
    v_sin_f32 v37, v49
    v_mul_f32 v20, v20, v44
    v_mul_f32 v21, v21, v44
    v_mul_f32 v34, v34, v46
    v_mul_f32 v35, v35, v46
    v_mul_f32 v36, v36, v48
    v_mul_f32 v37, v37, v48
    v_mov_b32 v64, 1.0
    v_mov_b32 v65, 0
    v_mov_b32 v66, v34
    v_mov_b32 v67, v35
    v_mul_f32 v50, v16, v14
    v_mul_f32 v52, v20, v20
    v_mul_f32 v54, v34, v34
    v_mul_f32 v56, v36, v36
    v_mul_f32 v51, v16, v15
    v_mul_f32 v53, v20, v21
    v_mul_f32 v55, v34, v35
    v_mul_f32 v57, v36, v37
    v_fma_f32 v96, -v17, v15, v50
    v_fma_f32 v22, -v21, v21, v52
    v_fma_f32 v38, -v35, v35, v54
    v_fma_f32 v40, -v37, v37, v56
    v_fma_f32 v97, v17, v14, v51
    v_fma_f32 v23, v21, v20, v53
    v_fma_f32 v39, v35, v34, v55
    v_fma_f32 v41, v37, v36, v57
    v_mul_f32 v50, v96, v36
    v_mul_f32 v52, v22, v20
    v_mul_f32 v54, v22, v22
    v_mul_f32 v56, v64, v38
    v_mul_f32 v58, v66, v38
    v_mul_f32 v51, v96, v37
    v_mul_f32 v53, v22, v21
    v_mul_f32 v55, v22, v23
    v_mul_f32 v57, v64, v39
    v_mul_f32 v59, v66, v39
    v_fma_f32 v98, -v97, v37, v50
    v_fma_f32 v24, -v23, v21, v52
    v_fma_f32 v26, -v23, v23, v54
    v_fma_f32 v68, -v65, v39, v56
    v_fma_f32 v70, -v67, v39, v58
    v_fma_f32 v99, v97, v36, v51
    v_fma_f32 v25, v23, v20, v53
    v_fma_f32 v27, v23, v22, v55
    v_fma_f32 v69, v65, v38, v57
    v_fma_f32 v71, v67, v38, v59
    v_mul_f32 v50, v96, v40
    v_mul_f32 v52, v98, v40
    v_mul_f32 v54, v26, v20
    v_mul_f32 v56, v26, v22
    v_mul_f32 v58, v26, v24
    v_mul_f32 v60, v68, v38
    v_mul_f32 v51, v96, v41
    v_mul_f32 v53, v98, v41
    v_mul_f32 v55, v26, v21
    v_mul_f32 v57, v26, v23
    v_mul_f32 v59, v26, v25
    v_mul_f32 v61, v68, v39
    v_fma_f32 v100, -v97, v41, v50
    v_fma_f32 v102, -v99, v41, v52
    v_fma_f32 v28, -v27, v21, v54
    v_fma_f32 v30, -v27, v23, v56
    v_fma_f32 v32, -v27, v25, v58
    v_fma_f32 v72, -v69, v39, v60
    v_fma_f32 v101, v97, v40, v51
    v_fma_f32 v103, v99, v40, v53
    v_fma_f32 v29, v27, v20, v55
    v_fma_f32 v31, v27, v22, v57
    v_fma_f32 v33, v27, v24, v59
    v_fma_f32 v73, v69, v38, v61
    v_cvt_pk_bf16_f32 v201, v64, v65
    v_cvt_pk_bf16_f32 v202, v66, v67
    v_cvt_pk_bf16_f32 v203, v68, v69
    v_cvt_pk_bf16_f32 v204, v70, v71
    v_cvt_pk_bf16_f32 v160, v96, -v97
    v_cvt_pk_bf16_f32 v168, v98, -v99
    v_cvt_pk_bf16_f32 v176, v100, -v101
    v_cvt_pk_bf16_f32 v180, v102, -v103
    v_mul_f32 v50, v100, v40
    v_mul_f32 v52, v102, v40
    v_mul_f32 v54, v70, v38
    v_mul_f32 v56, v72, v38
    v_mul_f32 v51, v100, v41
    v_mul_f32 v53, v102, v41
    v_mul_f32 v55, v70, v39
    v_mul_f32 v57, v72, v39
    v_fma_f32 v104, -v101, v41, v50
    v_fma_f32 v106, -v103, v41, v52
    v_fma_f32 v74, -v71, v39, v54
    v_fma_f32 v76, -v73, v39, v56
    v_fma_f32 v105, v101, v40, v51
    v_fma_f32 v107, v103, v40, v53
    v_fma_f32 v75, v71, v38, v55
    v_fma_f32 v77, v73, v38, v57
    v_mul_f32 v50, v104, v40
    v_mul_f32 v52, v106, v40
    v_mul_f32 v54, v74, v38
    v_mul_f32 v56, v76, v38
    v_mul_f32 v51, v104, v41
    v_mul_f32 v53, v106, v41
    v_mul_f32 v55, v74, v39
    v_mul_f32 v57, v76, v39
    v_fma_f32 v108, -v105, v41, v50
    v_fma_f32 v110, -v107, v41, v52
    v_fma_f32 v78, -v75, v39, v54
    v_fma_f32 v80, -v77, v39, v56
    v_fma_f32 v109, v105, v40, v51
    v_fma_f32 v111, v107, v40, v53
    v_fma_f32 v79, v75, v38, v55
    v_fma_f32 v81, v77, v38, v57
    v_mul_f32 v50, v108, v40
    v_mul_f32 v52, v110, v40
    v_mul_f32 v54, v78, v38
    v_mul_f32 v56, v80, v38
    v_mul_f32 v51, v108, v41
    v_mul_f32 v53, v110, v41
    v_mul_f32 v55, v78, v39
    v_mul_f32 v57, v80, v39
    v_fma_f32 v112, -v109, v41, v50
    v_fma_f32 v114, -v111, v41, v52
    v_fma_f32 v82, -v79, v39, v54
    v_fma_f32 v84, -v81, v39, v56
    v_fma_f32 v113, v109, v40, v51
    v_fma_f32 v115, v111, v40, v53
    v_fma_f32 v83, v79, v38, v55
    v_fma_f32 v85, v81, v38, v57
    v_mul_f32 v50, v112, v40
    v_mul_f32 v52, v114, v40
    v_mul_f32 v54, v82, v38
    v_mul_f32 v56, v84, v38
    v_mul_f32 v51, v112, v41
    v_mul_f32 v53, v114, v41
    v_mul_f32 v55, v82, v39
    v_mul_f32 v57, v84, v39
    v_fma_f32 v116, -v113, v41, v50
    v_fma_f32 v118, -v115, v41, v52
    v_fma_f32 v86, -v83, v39, v54
    v_fma_f32 v88, -v85, v39, v56
    v_fma_f32 v117, v113, v40, v51
    v_fma_f32 v119, v115, v40, v53
    v_fma_f32 v87, v83, v38, v55
    v_fma_f32 v89, v85, v38, v57
    v_mul_f32 v50, v116, v40
    v_mul_f32 v52, v118, v40
    v_mul_f32 v54, v86, v38
    v_mul_f32 v56, v88, v38
    v_mul_f32 v51, v116, v41
    v_mul_f32 v53, v118, v41
    v_mul_f32 v55, v86, v39
    v_mul_f32 v57, v88, v39
    v_fma_f32 v120, -v117, v41, v50
    v_fma_f32 v122, -v119, v41, v52
    v_fma_f32 v90, -v87, v39, v54
    v_fma_f32 v92, -v89, v39, v56
    v_fma_f32 v121, v117, v40, v51
    v_fma_f32 v123, v119, v40, v53
    v_fma_f32 v91, v87, v38, v55
    v_fma_f32 v93, v89, v38, v57
    v_mul_f32 v50, v120, v40
    v_mul_f32 v52, v122, v40
    v_mul_f32 v54, v90, v38
    v_mul_f32 v51, v120, v41
    v_mul_f32 v53, v122, v41
    v_mul_f32 v55, v90, v39
    v_fma_f32 v124, -v121, v41, v50
    v_fma_f32 v126, -v123, v41, v52
    v_fma_f32 v94, -v91, v39, v54
    v_fma_f32 v125, v121, v40, v51
    v_fma_f32 v127, v123, v40, v53
    v_fma_f32 v95, v91, v38, v55
    v_mul_f32 v50, v124, v40
    v_mul_f32 v51, v124, v41
    v_fma_f32 v128, -v125, v41, v50
    v_fma_f32 v129, v125, v40, v51
    v_cvt_pk_bf16_f32 v205, v72, v73
    v_cvt_pk_bf16_f32 v206, v74, v75
    v_cvt_pk_bf16_f32 v207, v76, v77
    v_cvt_pk_bf16_f32 v208, v78, v79
    v_cvt_pk_bf16_f32 v209, v80, v81
    v_cvt_pk_bf16_f32 v210, v82, v83
    v_cvt_pk_bf16_f32 v211, v84, v85
    v_cvt_pk_bf16_f32 v212, v86, v87
    v_cvt_pk_bf16_f32 v213, v88, v89
    v_cvt_pk_bf16_f32 v214, v90, v91
    v_cvt_pk_bf16_f32 v215, v92, v93
    v_cvt_pk_bf16_f32 v216, v94, v95
    v_cvt_pk_bf16_f32 v184, v104, -v105
    v_cvt_pk_bf16_f32 v186, v106, -v107
    v_cvt_pk_bf16_f32 v188, v108, -v109
    v_cvt_pk_bf16_f32 v190, v110, -v111
    v_cvt_pk_bf16_f32 v192, v112, -v113
    v_cvt_pk_bf16_f32 v193, v114, -v115
    v_cvt_pk_bf16_f32 v194, v116, -v117
    v_cvt_pk_bf16_f32 v195, v118, -v119
    v_cvt_pk_bf16_f32 v196, v120, -v121
    v_cvt_pk_bf16_f32 v197, v122, -v123
    v_cvt_pk_bf16_f32 v198, v124, -v125
    v_cvt_pk_bf16_f32 v199, v126, -v127
    v_cvt_pk_bf16_f32 v200, v128, -v129
    v_mul_f32 v50, v96, v20
    v_mul_f32 v52, v98, v20
    v_mul_f32 v54, v96, v22
    v_mul_f32 v56, v98, v22
    v_mul_f32 v58, v96, v24
    v_mul_f32 v60, v98, v24
    v_mul_f32 v51, v96, v21
    v_mul_f32 v53, v98, v21
    v_mul_f32 v55, v96, v23
    v_mul_f32 v57, v98, v23
    v_mul_f32 v59, v96, v25
    v_mul_f32 v61, v98, v25
    v_fma_f32 v130, -v97, v21, v50
    v_fma_f32 v132, -v99, v21, v52
    v_fma_f32 v134, -v97, v23, v54
    v_fma_f32 v136, -v99, v23, v56
    v_fma_f32 v138, -v97, v25, v58
    v_fma_f32 v140, -v99, v25, v60
    v_fma_f32 v131, v97, v20, v51
    v_fma_f32 v133, v99, v20, v53
    v_fma_f32 v135, v97, v22, v55
    v_fma_f32 v137, v99, v22, v57
    v_fma_f32 v139, v97, v24, v59
    v_fma_f32 v141, v99, v24, v61
    v_cvt_pk_bf16_f32 v161, v130, -v131
    v_cvt_pk_bf16_f32 v169, v132, -v133
    v_cvt_pk_bf16_f32 v162, v134, -v135
    v_cvt_pk_bf16_f32 v170, v136, -v137
    v_cvt_pk_bf16_f32 v163, v138, -v139
    v_cvt_pk_bf16_f32 v171, v140, -v141
    v_mul_f32 v50, v96, v26
    v_mul_f32 v52, v98, v26
    v_mul_f32 v54, v96, v28
    v_mul_f32 v56, v98, v28
    v_mul_f32 v58, v96, v30
    v_mul_f32 v60, v98, v30
    v_mul_f32 v51, v96, v27
    v_mul_f32 v53, v98, v27
    v_mul_f32 v55, v96, v29
    v_mul_f32 v57, v98, v29
    v_mul_f32 v59, v96, v31
    v_mul_f32 v61, v98, v31
    v_fma_f32 v130, -v97, v27, v50
    v_fma_f32 v132, -v99, v27, v52
    v_fma_f32 v134, -v97, v29, v54
    v_fma_f32 v136, -v99, v29, v56
    v_fma_f32 v138, -v97, v31, v58
    v_fma_f32 v140, -v99, v31, v60
    v_fma_f32 v131, v97, v26, v51
    v_fma_f32 v133, v99, v26, v53
    v_fma_f32 v135, v97, v28, v55
    v_fma_f32 v137, v99, v28, v57
    v_fma_f32 v139, v97, v30, v59
    v_fma_f32 v141, v99, v30, v61
    v_cvt_pk_bf16_f32 v164, v130, -v131
    v_cvt_pk_bf16_f32 v172, v132, -v133
    v_cvt_pk_bf16_f32 v165, v134, -v135
    v_cvt_pk_bf16_f32 v173, v136, -v137
    v_cvt_pk_bf16_f32 v166, v138, -v139
    v_cvt_pk_bf16_f32 v174, v140, -v141
    v_mul_f32 v50, v96, v32
    v_mul_f32 v52, v98, v32
    v_mul_f32 v54, v100, v22
    v_mul_f32 v56, v102, v22
    v_mul_f32 v58, v100, v26
    v_mul_f32 v60, v102, v26
    v_mul_f32 v51, v96, v33
    v_mul_f32 v53, v98, v33
    v_mul_f32 v55, v100, v23
    v_mul_f32 v57, v102, v23
    v_mul_f32 v59, v100, v27
    v_mul_f32 v61, v102, v27
    v_fma_f32 v130, -v97, v33, v50
    v_fma_f32 v132, -v99, v33, v52
    v_fma_f32 v134, -v101, v23, v54
    v_fma_f32 v136, -v103, v23, v56
    v_fma_f32 v138, -v101, v27, v58
    v_fma_f32 v140, -v103, v27, v60
    v_fma_f32 v131, v97, v32, v51
    v_fma_f32 v133, v99, v32, v53
    v_fma_f32 v135, v101, v22, v55
    v_fma_f32 v137, v103, v22, v57
    v_fma_f32 v139, v101, v26, v59
    v_fma_f32 v141, v103, v26, v61
    v_cvt_pk_bf16_f32 v167, v130, -v131
    v_cvt_pk_bf16_f32 v175, v132, -v133
    v_cvt_pk_bf16_f32 v177, v134, -v135
    v_cvt_pk_bf16_f32 v181, v136, -v137
    v_cvt_pk_bf16_f32 v178, v138, -v139
    v_cvt_pk_bf16_f32 v182, v140, -v141
    v_mul_f32 v50, v100, v30
    v_mul_f32 v52, v102, v30
    v_mul_f32 v54, v104, v26
    v_mul_f32 v56, v106, v26
    v_mul_f32 v58, v108, v26
    v_mul_f32 v60, v110, v26
    v_mul_f32 v51, v100, v31
    v_mul_f32 v53, v102, v31
    v_mul_f32 v55, v104, v27
    v_mul_f32 v57, v106, v27
    v_mul_f32 v59, v108, v27
    v_mul_f32 v61, v110, v27
    v_fma_f32 v130, -v101, v31, v50
    v_fma_f32 v132, -v103, v31, v52
    v_fma_f32 v134, -v105, v27, v54
    v_fma_f32 v136, -v107, v27, v56
    v_fma_f32 v138, -v109, v27, v58
    v_fma_f32 v140, -v111, v27, v60
    v_fma_f32 v131, v101, v30, v51
    v_fma_f32 v133, v103, v30, v53
    v_fma_f32 v135, v105, v26, v55
    v_fma_f32 v137, v107, v26, v57
    v_fma_f32 v139, v109, v26, v59
    v_fma_f32 v141, v111, v26, v61
    v_cvt_pk_bf16_f32 v179, v130, -v131
    v_cvt_pk_bf16_f32 v183, v132, -v133
    v_cvt_pk_bf16_f32 v185, v134, -v135
    v_cvt_pk_bf16_f32 v187, v136, -v137
    v_cvt_pk_bf16_f32 v189, v138, -v139
    v_cvt_pk_bf16_f32 v191, v140, -v141
    s_and_b32 s92, s36, 1
    s_lshl_b32 s92, s92, 10
    v_lshlrev_b32 v44, 4, v1
    v_add_u32 v44, s92, v44
    v_sub_u32 v44, 2047, v44
    v_subrev_u32 v228, 0, v44
    v_subrev_u32 v229, 1, v44
    v_subrev_u32 v230, 2, v44
    v_subrev_u32 v231, 3, v44
    v_subrev_u32 v232, 4, v44
    v_subrev_u32 v233, 5, v44
    v_subrev_u32 v234, 6, v44
    v_subrev_u32 v235, 7, v44
    v_subrev_u32 v236, 8, v44
    v_subrev_u32 v237, 9, v44
    v_subrev_u32 v238, 10, v44
    v_subrev_u32 v239, 11, v44
    v_subrev_u32 v240, 12, v44
    v_subrev_u32 v241, 13, v44
    v_subrev_u32 v242, 14, v44
    v_subrev_u32 v243, 15, v44
    v_subrev_u32 v244, 16, v44
    v_cvt_f32_i32 v46, v228
    v_cvt_f32_i32 v47, v229
    v_cvt_pk_bf16_f32 v46, v46, v47
    v_lshrrev_b32 v47, 16, v46
    v_and_b32 v46, 0xffff, v46
    v_subrev_u32 v46, 17024, v46
    v_subrev_u32 v47, 17024, v47
    v_cmp_gt_i32 vcc, 128, v228
    s_nop 1
    v_cndmask_b32 v228, v46, v228, vcc
    v_cmp_gt_i32 vcc, 128, v229
    s_nop 1
    v_cndmask_b32 v229, v47, v229, vcc
    v_cvt_f32_i32 v48, v230
    v_cvt_f32_i32 v49, v231
    v_cvt_pk_bf16_f32 v48, v48, v49
    v_lshrrev_b32 v49, 16, v48
    v_and_b32 v48, 0xffff, v48
    v_subrev_u32 v48, 17024, v48
    v_subrev_u32 v49, 17024, v49
    v_cmp_gt_i32 vcc, 128, v230
    s_nop 1
    v_cndmask_b32 v230, v48, v230, vcc
    v_cmp_gt_i32 vcc, 128, v231
    s_nop 1
    v_cndmask_b32 v231, v49, v231, vcc
    v_cvt_f32_i32 v50, v232
    v_cvt_f32_i32 v51, v233
    v_cvt_pk_bf16_f32 v50, v50, v51
    v_lshrrev_b32 v51, 16, v50
    v_and_b32 v50, 0xffff, v50
    v_subrev_u32 v50, 17024, v50
    v_subrev_u32 v51, 17024, v51
    v_cmp_gt_i32 vcc, 128, v232
    s_nop 1
    v_cndmask_b32 v232, v50, v232, vcc
    v_cmp_gt_i32 vcc, 128, v233
    s_nop 1
    v_cndmask_b32 v233, v51, v233, vcc
    v_cvt_f32_i32 v52, v234
    v_cvt_f32_i32 v53, v235
    v_cvt_pk_bf16_f32 v52, v52, v53
    v_lshrrev_b32 v53, 16, v52
    v_and_b32 v52, 0xffff, v52
    v_subrev_u32 v52, 17024, v52
    v_subrev_u32 v53, 17024, v53
    v_cmp_gt_i32 vcc, 128, v234
    s_nop 1
    v_cndmask_b32 v234, v52, v234, vcc
    v_cmp_gt_i32 vcc, 128, v235
    s_nop 1
    v_cndmask_b32 v235, v53, v235, vcc
    v_cvt_f32_i32 v46, v236
    v_cvt_f32_i32 v47, v237
    v_cvt_pk_bf16_f32 v46, v46, v47
    v_lshrrev_b32 v47, 16, v46
    v_and_b32 v46, 0xffff, v46
    v_subrev_u32 v46, 17024, v46
    v_subrev_u32 v47, 17024, v47
    v_cmp_gt_i32 vcc, 128, v236
    s_nop 1
    v_cndmask_b32 v236, v46, v236, vcc
    v_cmp_gt_i32 vcc, 128, v237
    s_nop 1
    v_cndmask_b32 v237, v47, v237, vcc
    v_cvt_f32_i32 v48, v238
    v_cvt_f32_i32 v49, v239
    v_cvt_pk_bf16_f32 v48, v48, v49
    v_lshrrev_b32 v49, 16, v48
    v_and_b32 v48, 0xffff, v48
    v_subrev_u32 v48, 17024, v48
    v_subrev_u32 v49, 17024, v49
    v_cmp_gt_i32 vcc, 128, v238
    s_nop 1
    v_cndmask_b32 v238, v48, v238, vcc
    v_cmp_gt_i32 vcc, 128, v239
    s_nop 1
    v_cndmask_b32 v239, v49, v239, vcc
    v_cvt_f32_i32 v50, v240
    v_cvt_f32_i32 v51, v241
    v_cvt_pk_bf16_f32 v50, v50, v51
    v_lshrrev_b32 v51, 16, v50
    v_and_b32 v50, 0xffff, v50
    v_subrev_u32 v50, 17024, v50
    v_subrev_u32 v51, 17024, v51
    v_cmp_gt_i32 vcc, 128, v240
    s_nop 1
    v_cndmask_b32 v240, v50, v240, vcc
    v_cmp_gt_i32 vcc, 128, v241
    s_nop 1
    v_cndmask_b32 v241, v51, v241, vcc
    v_cvt_f32_i32 v52, v242
    v_cvt_f32_i32 v53, v243
    v_cvt_pk_bf16_f32 v52, v52, v53
    v_lshrrev_b32 v53, 16, v52
    v_and_b32 v52, 0xffff, v52
    v_subrev_u32 v52, 17024, v52
    v_subrev_u32 v53, 17024, v53
    v_cmp_gt_i32 vcc, 128, v242
    s_nop 1
    v_cndmask_b32 v242, v52, v242, vcc
    v_cmp_gt_i32 vcc, 128, v243
    s_nop 1
    v_cndmask_b32 v243, v53, v243, vcc
    v_cvt_f32_i32 v46, v244
    v_cvt_f32_i32 v47, v244
    v_cvt_pk_bf16_f32 v46, v46, v47
    v_lshrrev_b32 v47, 16, v46
    v_and_b32 v46, 0xffff, v46
    v_subrev_u32 v46, 17024, v46
    v_subrev_u32 v47, 17024, v47
    v_cmp_gt_i32 vcc, 128, v244
    s_nop 1
    v_cndmask_b32 v244, v46, v244, vcc
    v_cmp_gt_i32 vcc, 0, v244
    v_mov_b32 v46, 641
    s_nop 0
    v_cndmask_b32 v244, v244, v46, vcc
    v_lshlrev_b32 v228, 1, v228
    v_lshlrev_b32 v229, 1, v229
    v_lshlrev_b32 v230, 1, v230
    v_lshlrev_b32 v231, 1, v231
    v_lshlrev_b32 v232, 1, v232
    v_lshlrev_b32 v233, 1, v233
    v_lshlrev_b32 v234, 1, v234
    v_lshlrev_b32 v235, 1, v235
    v_lshlrev_b32 v236, 1, v236
    v_lshlrev_b32 v237, 1, v237
    v_lshlrev_b32 v238, 1, v238
    v_lshlrev_b32 v239, 1, v239
    v_lshlrev_b32 v240, 1, v240
    v_lshlrev_b32 v241, 1, v241
    v_lshlrev_b32 v242, 1, v242
    v_lshlrev_b32 v243, 1, v243
    v_lshlrev_b32 v244, 1, v244
    v_mov_b32 v8, 0
    s_branch B_CONV
B_GEMM2:
    s_nop 15
    s_nop 3
    s_lshl_b32 s39, s37, 2
    s_lshr_b32 s3, s38, 3
    s_add_u32 s39, s39, s3
    s_and_b32 s3, s38, 7
    s_mov_b32 s12, s96
    s_mov_b32 s13, s97
    s_mov_b32 s14, 0x200000
    s_mov_b32 s15, 0x00020000
    v_lshrrev_b32 v5, 3, v1
    v_lshlrev_b32 v5, 10, v5
    v_and_b32 v6, 7, v1
    v_lshl_add_u32 v5, v6, 4, v5
    s_lshl_b32 s34, s39, 16
    s_lshl_b32 s35, s36, 13
    s_add_u32 s34, s34, s35
    s_lshl_b32 s35, s3, 7
    s_add_u32 s34, s34, s35
    buffer_load_dwordx4 v[252:255], v5, s[8:11], s34 offen
    v_lshlrev_b32 v2, 4, v1
    v_add_u32 v12, 0, v2
    v_add_u32 v13, 4096, v2
    v_add_u32 v14, 8192, v2
    v_add_u32 v15, 12288, v2
    v_add_u32 v16, 16384, v2
    v_add_u32 v17, 20480, v2
    v_add_u32 v18, 24576, v2
    s_mul_i32 s26, s39, 224
    s_mul_i32 s27, s36, 28
    s_add_u32 s26, s26, s27
    s_lshl_b32 s26, s26, 10
    s_add_u32 s28, s26, 114688
    s_mul_i32 s29, s3, 224
    s_add_u32 s29, s29, s27
    s_lshl_b32 s29, s29, 10
    s_add_u32 s29, s29, 7340032
    s_add_u32 s30, s29, 114688
    v_mov_b32 v20, 150148
B_WWAIT:
    ds_read_b32 v21, v20
    s_waitcnt lgkmcnt(0)
    v_readfirstlane_b32 s92, v21
    s_nop 0
    s_cmp_eq_u32 s92, 0
    s_cbranch_scc0 B_WWAIT_OK
    s_sleep 2
    s_branch B_WWAIT
B_WWAIT_OK:
    buffer_load_dwordx4 v[24:27], v12, s[20:23], s29 offen offset:0 sc1
    buffer_load_dwordx4 v[28:31], v12, s[20:23], s30 offen offset:0 sc1
    buffer_load_dwordx4 v[32:35], v12, s[20:23], s29 offen offset:1024 sc1
    buffer_load_dwordx4 v[36:39], v12, s[20:23], s30 offen offset:1024 sc1
    buffer_load_dwordx4 v[40:43], v12, s[20:23], s29 offen offset:2048 sc1
    buffer_load_dwordx4 v[44:47], v12, s[20:23], s30 offen offset:2048 sc1
    buffer_load_dwordx4 v[48:51], v12, s[20:23], s29 offen offset:3072 sc1
    buffer_load_dwordx4 v[52:55], v12, s[20:23], s30 offen offset:3072 sc1
    buffer_load_dwordx4 v[56:59], v13, s[20:23], s29 offen offset:0 sc1
    buffer_load_dwordx4 v[60:63], v13, s[20:23], s30 offen offset:0 sc1
    buffer_load_dwordx4 v[64:67], v13, s[20:23], s29 offen offset:1024 sc1
    buffer_load_dwordx4 v[68:71], v13, s[20:23], s30 offen offset:1024 sc1
    buffer_load_dwordx4 v[72:75], v13, s[20:23], s29 offen offset:2048 sc1
    buffer_load_dwordx4 v[76:79], v13, s[20:23], s30 offen offset:2048 sc1
    buffer_load_dwordx4 v[80:83], v13, s[20:23], s29 offen offset:3072 sc1
    buffer_load_dwordx4 v[84:87], v13, s[20:23], s30 offen offset:3072 sc1
    buffer_load_dwordx4 v[88:91], v14, s[20:23], s29 offen offset:0 sc1
    buffer_load_dwordx4 v[92:95], v14, s[20:23], s30 offen offset:0 sc1
    buffer_load_dwordx4 v[96:99], v14, s[20:23], s29 offen offset:1024 sc1
    buffer_load_dwordx4 v[100:103], v14, s[20:23], s30 offen offset:1024 sc1
    buffer_load_dwordx4 v[104:107], v14, s[20:23], s29 offen offset:2048 sc1
    buffer_load_dwordx4 v[108:111], v14, s[20:23], s30 offen offset:2048 sc1
    v_and_b32 v22, 31, v1
    v_lshlrev_b32 v19, 2, v22
    s_lshl_b32 s27, s37, 7
    s_add_u32 s27, s27, 13369344
    v_add_u32 v19, s27, v19
    v_cmp_gt_u32 vcc, 28, v22
    v_mov_b32 v20, 0
    v_mov_b32 v21, 1
    v_cndmask_b32 v20, v20, v21, vcc
    v_mov_b32 v22, 150152
    s_cmp_lg_u32 s36, 0
    s_cbranch_scc1 B_GWAIT
B_GPOLL:
    buffer_load_dword v23, v19, s[20:23], 0 offen sc1
    s_waitcnt vmcnt(0)
    v_and_b32 v23, v23, v20
    v_cmp_ne_u32 vcc, v23, v20
    s_nop 4
    s_cbranch_vccz B_GPOLL_OK
    s_sleep 2
    s_branch B_GPOLL
B_GPOLL_OK:
    ds_write_b32 v22, v21
    s_branch B_GGO
B_GWAIT:
    ds_read_b32 v23, v22
    s_waitcnt lgkmcnt(0)
    v_readfirstlane_b32 s92, v23
    s_nop 0
    s_cmp_eq_u32 s92, 0
    s_cbranch_scc0 B_GWAIT_OK
    s_sleep 1
    s_branch B_GWAIT
B_GWAIT_OK:
B_GGO:
    buffer_load_dwordx4 v[112:115], v12, s[20:23], s26 offen offset:0 sc1
    buffer_load_dwordx4 v[116:119], v12, s[20:23], s28 offen offset:0 sc1
    buffer_load_dwordx4 v[120:123], v12, s[20:23], s26 offen offset:1024 sc1
    buffer_load_dwordx4 v[124:127], v12, s[20:23], s28 offen offset:1024 sc1
    buffer_load_dwordx4 v[128:131], v12, s[20:23], s26 offen offset:2048 sc1
    buffer_load_dwordx4 v[132:135], v12, s[20:23], s28 offen offset:2048 sc1
    buffer_load_dwordx4 v[136:139], v12, s[20:23], s26 offen offset:3072 sc1
    buffer_load_dwordx4 v[140:143], v12, s[20:23], s28 offen offset:3072 sc1
    buffer_load_dwordx4 v[144:147], v13, s[20:23], s26 offen offset:0 sc1
    buffer_load_dwordx4 v[148:151], v13, s[20:23], s28 offen offset:0 sc1
    buffer_load_dwordx4 v[152:155], v13, s[20:23], s26 offen offset:1024 sc1
    buffer_load_dwordx4 v[156:159], v13, s[20:23], s28 offen offset:1024 sc1
    buffer_load_dwordx4 v[160:163], v13, s[20:23], s26 offen offset:2048 sc1
    buffer_load_dwordx4 v[164:167], v13, s[20:23], s28 offen offset:2048 sc1
    buffer_load_dwordx4 v[168:171], v13, s[20:23], s26 offen offset:3072 sc1
    buffer_load_dwordx4 v[172:175], v13, s[20:23], s28 offen offset:3072 sc1
    s_waitcnt vmcnt(14)
    v_mfma_f32_32x32x16_bf16 v[176:191], v[24:27], v[112:115], 0
    v_mfma_f32_32x32x16_bf16 v[192:207], v[24:27], v[116:119], 0
    v_mfma_f32_32x32x16_bf16 v[208:223], v[28:31], v[112:115], 0
    v_mfma_f32_32x32x16_bf16 v[224:239], v[28:31], v[116:119], 0
    buffer_load_dwordx4 v[112:115], v14, s[20:23], s26 offen offset:0 sc1
    buffer_load_dwordx4 v[116:119], v14, s[20:23], s28 offen offset:0 sc1
    buffer_load_dwordx4 v[24:27], v14, s[20:23], s29 offen offset:3072 sc1
    buffer_load_dwordx4 v[28:31], v14, s[20:23], s30 offen offset:3072 sc1
    s_waitcnt vmcnt(16)
    v_mfma_f32_32x32x16_bf16 v[176:191], v[32:35], v[120:123], v[176:191]
    v_mfma_f32_32x32x16_bf16 v[192:207], v[32:35], v[124:127], v[192:207]
    v_mfma_f32_32x32x16_bf16 v[208:223], v[36:39], v[120:123], v[208:223]
    v_mfma_f32_32x32x16_bf16 v[224:239], v[36:39], v[124:127], v[224:239]
    buffer_load_dwordx4 v[120:123], v14, s[20:23], s26 offen offset:1024 sc1
    buffer_load_dwordx4 v[124:127], v14, s[20:23], s28 offen offset:1024 sc1
    buffer_load_dwordx4 v[32:35], v15, s[20:23], s29 offen offset:0 sc1
    buffer_load_dwordx4 v[36:39], v15, s[20:23], s30 offen offset:0 sc1
    s_waitcnt vmcnt(18)
    v_mfma_f32_32x32x16_bf16 v[176:191], v[40:43], v[128:131], v[176:191]
    v_mfma_f32_32x32x16_bf16 v[192:207], v[40:43], v[132:135], v[192:207]
    v_mfma_f32_32x32x16_bf16 v[208:223], v[44:47], v[128:131], v[208:223]
    v_mfma_f32_32x32x16_bf16 v[224:239], v[44:47], v[132:135], v[224:239]
    buffer_load_dwordx4 v[128:131], v14, s[20:23], s26 offen offset:2048 sc1
    buffer_load_dwordx4 v[132:135], v14, s[20:23], s28 offen offset:2048 sc1
    buffer_load_dwordx4 v[40:43], v15, s[20:23], s29 offen offset:1024 sc1
    buffer_load_dwordx4 v[44:47], v15, s[20:23], s30 offen offset:1024 sc1
    s_waitcnt vmcnt(20)
    v_mfma_f32_32x32x16_bf16 v[176:191], v[48:51], v[136:139], v[176:191]
    v_mfma_f32_32x32x16_bf16 v[192:207], v[48:51], v[140:143], v[192:207]
    v_mfma_f32_32x32x16_bf16 v[208:223], v[52:55], v[136:139], v[208:223]
    v_mfma_f32_32x32x16_bf16 v[224:239], v[52:55], v[140:143], v[224:239]
    buffer_load_dwordx4 v[136:139], v14, s[20:23], s26 offen offset:3072 sc1
    buffer_load_dwordx4 v[140:143], v14, s[20:23], s28 offen offset:3072 sc1
    buffer_load_dwordx4 v[48:51], v15, s[20:23], s29 offen offset:2048 sc1
    buffer_load_dwordx4 v[52:55], v15, s[20:23], s30 offen offset:2048 sc1
    s_waitcnt vmcnt(22)
    v_mfma_f32_32x32x16_bf16 v[176:191], v[56:59], v[144:147], v[176:191]
    v_mfma_f32_32x32x16_bf16 v[192:207], v[56:59], v[148:151], v[192:207]
    v_mfma_f32_32x32x16_bf16 v[208:223], v[60:63], v[144:147], v[208:223]
    v_mfma_f32_32x32x16_bf16 v[224:239], v[60:63], v[148:151], v[224:239]
    buffer_load_dwordx4 v[144:147], v15, s[20:23], s26 offen offset:0 sc1
    buffer_load_dwordx4 v[148:151], v15, s[20:23], s28 offen offset:0 sc1
    buffer_load_dwordx4 v[56:59], v15, s[20:23], s29 offen offset:3072 sc1
    buffer_load_dwordx4 v[60:63], v15, s[20:23], s30 offen offset:3072 sc1
    s_waitcnt vmcnt(24)
    v_mfma_f32_32x32x16_bf16 v[176:191], v[64:67], v[152:155], v[176:191]
    v_mfma_f32_32x32x16_bf16 v[192:207], v[64:67], v[156:159], v[192:207]
    v_mfma_f32_32x32x16_bf16 v[208:223], v[68:71], v[152:155], v[208:223]
    v_mfma_f32_32x32x16_bf16 v[224:239], v[68:71], v[156:159], v[224:239]
    buffer_load_dwordx4 v[152:155], v15, s[20:23], s26 offen offset:1024 sc1
    buffer_load_dwordx4 v[156:159], v15, s[20:23], s28 offen offset:1024 sc1
    buffer_load_dwordx4 v[64:67], v16, s[20:23], s29 offen offset:0 sc1
    buffer_load_dwordx4 v[68:71], v16, s[20:23], s30 offen offset:0 sc1
    s_waitcnt vmcnt(26)
    v_mfma_f32_32x32x16_bf16 v[176:191], v[72:75], v[160:163], v[176:191]
    v_mfma_f32_32x32x16_bf16 v[192:207], v[72:75], v[164:167], v[192:207]
    v_mfma_f32_32x32x16_bf16 v[208:223], v[76:79], v[160:163], v[208:223]
    v_mfma_f32_32x32x16_bf16 v[224:239], v[76:79], v[164:167], v[224:239]
    buffer_load_dwordx4 v[160:163], v15, s[20:23], s26 offen offset:2048 sc1
    buffer_load_dwordx4 v[164:167], v15, s[20:23], s28 offen offset:2048 sc1
    buffer_load_dwordx4 v[72:75], v16, s[20:23], s29 offen offset:1024 sc1
    buffer_load_dwordx4 v[76:79], v16, s[20:23], s30 offen offset:1024 sc1
    s_waitcnt vmcnt(28)
    v_mfma_f32_32x32x16_bf16 v[176:191], v[80:83], v[168:171], v[176:191]
    v_mfma_f32_32x32x16_bf16 v[192:207], v[80:83], v[172:175], v[192:207]
    v_mfma_f32_32x32x16_bf16 v[208:223], v[84:87], v[168:171], v[208:223]
    v_mfma_f32_32x32x16_bf16 v[224:239], v[84:87], v[172:175], v[224:239]
    buffer_load_dwordx4 v[168:171], v15, s[20:23], s26 offen offset:3072 sc1
    buffer_load_dwordx4 v[172:175], v15, s[20:23], s28 offen offset:3072 sc1
    buffer_load_dwordx4 v[80:83], v16, s[20:23], s29 offen offset:2048 sc1
    buffer_load_dwordx4 v[84:87], v16, s[20:23], s30 offen offset:2048 sc1
    s_waitcnt vmcnt(30)
    v_mfma_f32_32x32x16_bf16 v[176:191], v[88:91], v[112:115], v[176:191]
    v_mfma_f32_32x32x16_bf16 v[192:207], v[88:91], v[116:119], v[192:207]
    v_mfma_f32_32x32x16_bf16 v[208:223], v[92:95], v[112:115], v[208:223]
    v_mfma_f32_32x32x16_bf16 v[224:239], v[92:95], v[116:119], v[224:239]
    buffer_load_dwordx4 v[112:115], v16, s[20:23], s26 offen offset:0 sc1
    buffer_load_dwordx4 v[116:119], v16, s[20:23], s28 offen offset:0 sc1
    buffer_load_dwordx4 v[88:91], v16, s[20:23], s29 offen offset:3072 sc1
    buffer_load_dwordx4 v[92:95], v16, s[20:23], s30 offen offset:3072 sc1
    s_waitcnt vmcnt(30)
    v_mfma_f32_32x32x16_bf16 v[176:191], v[96:99], v[120:123], v[176:191]
    v_mfma_f32_32x32x16_bf16 v[192:207], v[96:99], v[124:127], v[192:207]
    v_mfma_f32_32x32x16_bf16 v[208:223], v[100:103], v[120:123], v[208:223]
    v_mfma_f32_32x32x16_bf16 v[224:239], v[100:103], v[124:127], v[224:239]
    buffer_load_dwordx4 v[120:123], v16, s[20:23], s26 offen offset:1024 sc1
    buffer_load_dwordx4 v[124:127], v16, s[20:23], s28 offen offset:1024 sc1
    buffer_load_dwordx4 v[96:99], v17, s[20:23], s29 offen offset:0 sc1
    buffer_load_dwordx4 v[100:103], v17, s[20:23], s30 offen offset:0 sc1
    s_waitcnt vmcnt(30)
    v_mfma_f32_32x32x16_bf16 v[176:191], v[104:107], v[128:131], v[176:191]
    v_mfma_f32_32x32x16_bf16 v[192:207], v[104:107], v[132:135], v[192:207]
    v_mfma_f32_32x32x16_bf16 v[208:223], v[108:111], v[128:131], v[208:223]
    v_mfma_f32_32x32x16_bf16 v[224:239], v[108:111], v[132:135], v[224:239]
    buffer_load_dwordx4 v[128:131], v16, s[20:23], s26 offen offset:2048 sc1
    buffer_load_dwordx4 v[132:135], v16, s[20:23], s28 offen offset:2048 sc1
    buffer_load_dwordx4 v[104:107], v17, s[20:23], s29 offen offset:1024 sc1
    buffer_load_dwordx4 v[108:111], v17, s[20:23], s30 offen offset:1024 sc1
    s_waitcnt vmcnt(30)
    v_mfma_f32_32x32x16_bf16 v[176:191], v[24:27], v[136:139], v[176:191]
    v_mfma_f32_32x32x16_bf16 v[192:207], v[24:27], v[140:143], v[192:207]
    v_mfma_f32_32x32x16_bf16 v[208:223], v[28:31], v[136:139], v[208:223]
    v_mfma_f32_32x32x16_bf16 v[224:239], v[28:31], v[140:143], v[224:239]
    buffer_load_dwordx4 v[136:139], v16, s[20:23], s26 offen offset:3072 sc1
    buffer_load_dwordx4 v[140:143], v16, s[20:23], s28 offen offset:3072 sc1
    buffer_load_dwordx4 v[24:27], v17, s[20:23], s29 offen offset:2048 sc1
    buffer_load_dwordx4 v[28:31], v17, s[20:23], s30 offen offset:2048 sc1
    s_waitcnt vmcnt(30)
    v_mfma_f32_32x32x16_bf16 v[176:191], v[32:35], v[144:147], v[176:191]
    v_mfma_f32_32x32x16_bf16 v[192:207], v[32:35], v[148:151], v[192:207]
    v_mfma_f32_32x32x16_bf16 v[208:223], v[36:39], v[144:147], v[208:223]
    v_mfma_f32_32x32x16_bf16 v[224:239], v[36:39], v[148:151], v[224:239]
    buffer_load_dwordx4 v[144:147], v17, s[20:23], s26 offen offset:0 sc1
    buffer_load_dwordx4 v[148:151], v17, s[20:23], s28 offen offset:0 sc1
    buffer_load_dwordx4 v[32:35], v17, s[20:23], s29 offen offset:3072 sc1
    buffer_load_dwordx4 v[36:39], v17, s[20:23], s30 offen offset:3072 sc1
    s_waitcnt vmcnt(30)
    v_mfma_f32_32x32x16_bf16 v[176:191], v[40:43], v[152:155], v[176:191]
    v_mfma_f32_32x32x16_bf16 v[192:207], v[40:43], v[156:159], v[192:207]
    v_mfma_f32_32x32x16_bf16 v[208:223], v[44:47], v[152:155], v[208:223]
    v_mfma_f32_32x32x16_bf16 v[224:239], v[44:47], v[156:159], v[224:239]
    buffer_load_dwordx4 v[152:155], v17, s[20:23], s26 offen offset:1024 sc1
    buffer_load_dwordx4 v[156:159], v17, s[20:23], s28 offen offset:1024 sc1
    buffer_load_dwordx4 v[40:43], v18, s[20:23], s29 offen offset:0 sc1
    buffer_load_dwordx4 v[44:47], v18, s[20:23], s30 offen offset:0 sc1
    s_waitcnt vmcnt(30)
    v_mfma_f32_32x32x16_bf16 v[176:191], v[48:51], v[160:163], v[176:191]
    v_mfma_f32_32x32x16_bf16 v[192:207], v[48:51], v[164:167], v[192:207]
    v_mfma_f32_32x32x16_bf16 v[208:223], v[52:55], v[160:163], v[208:223]
    v_mfma_f32_32x32x16_bf16 v[224:239], v[52:55], v[164:167], v[224:239]
    buffer_load_dwordx4 v[160:163], v17, s[20:23], s26 offen offset:2048 sc1
    buffer_load_dwordx4 v[164:167], v17, s[20:23], s28 offen offset:2048 sc1
    buffer_load_dwordx4 v[48:51], v18, s[20:23], s29 offen offset:1024 sc1
    buffer_load_dwordx4 v[52:55], v18, s[20:23], s30 offen offset:1024 sc1
    s_cmp_lg_u32 s36, 0
    s_cbranch_scc1 W0_39
    v_mov_b32 v2, 150144
    v_mov_b32 v3, 1
    ds_write_b32 v2, v3
W0_39:
    s_waitcnt vmcnt(30)
    v_mfma_f32_32x32x16_bf16 v[176:191], v[56:59], v[168:171], v[176:191]
    v_mfma_f32_32x32x16_bf16 v[192:207], v[56:59], v[172:175], v[192:207]
    v_mfma_f32_32x32x16_bf16 v[208:223], v[60:63], v[168:171], v[208:223]
    v_mfma_f32_32x32x16_bf16 v[224:239], v[60:63], v[172:175], v[224:239]
    buffer_load_dwordx4 v[168:171], v17, s[20:23], s26 offen offset:3072 sc1
    buffer_load_dwordx4 v[172:175], v17, s[20:23], s28 offen offset:3072 sc1
    buffer_load_dwordx4 v[56:59], v18, s[20:23], s29 offen offset:2048 sc1
    buffer_load_dwordx4 v[60:63], v18, s[20:23], s30 offen offset:2048 sc1
    s_waitcnt vmcnt(30)
    v_mfma_f32_32x32x16_bf16 v[176:191], v[64:67], v[112:115], v[176:191]
    v_mfma_f32_32x32x16_bf16 v[192:207], v[64:67], v[116:119], v[192:207]
    v_mfma_f32_32x32x16_bf16 v[208:223], v[68:71], v[112:115], v[208:223]
    v_mfma_f32_32x32x16_bf16 v[224:239], v[68:71], v[116:119], v[224:239]
    buffer_load_dwordx4 v[112:115], v18, s[20:23], s26 offen offset:0 sc1
    buffer_load_dwordx4 v[116:119], v18, s[20:23], s28 offen offset:0 sc1
    buffer_load_dwordx4 v[64:67], v18, s[20:23], s29 offen offset:3072 sc1
    buffer_load_dwordx4 v[68:71], v18, s[20:23], s30 offen offset:3072 sc1
    s_waitcnt vmcnt(30)
    v_mfma_f32_32x32x16_bf16 v[176:191], v[72:75], v[120:123], v[176:191]
    v_mfma_f32_32x32x16_bf16 v[192:207], v[72:75], v[124:127], v[192:207]
    v_mfma_f32_32x32x16_bf16 v[208:223], v[76:79], v[120:123], v[208:223]
    v_mfma_f32_32x32x16_bf16 v[224:239], v[76:79], v[124:127], v[224:239]
    buffer_load_dwordx4 v[120:123], v18, s[20:23], s26 offen offset:1024 sc1
    buffer_load_dwordx4 v[124:127], v18, s[20:23], s28 offen offset:1024 sc1
    s_waitcnt vmcnt(28)
    v_mfma_f32_32x32x16_bf16 v[176:191], v[80:83], v[128:131], v[176:191]
    v_mfma_f32_32x32x16_bf16 v[192:207], v[80:83], v[132:135], v[192:207]
    v_mfma_f32_32x32x16_bf16 v[208:223], v[84:87], v[128:131], v[208:223]
    v_mfma_f32_32x32x16_bf16 v[224:239], v[84:87], v[132:135], v[224:239]
    buffer_load_dwordx4 v[128:131], v18, s[20:23], s26 offen offset:2048 sc1
    buffer_load_dwordx4 v[132:135], v18, s[20:23], s28 offen offset:2048 sc1
    s_waitcnt vmcnt(26)
    v_mfma_f32_32x32x16_bf16 v[176:191], v[88:91], v[136:139], v[176:191]
    v_mfma_f32_32x32x16_bf16 v[192:207], v[88:91], v[140:143], v[192:207]
    v_mfma_f32_32x32x16_bf16 v[208:223], v[92:95], v[136:139], v[208:223]
    v_mfma_f32_32x32x16_bf16 v[224:239], v[92:95], v[140:143], v[224:239]
    buffer_load_dwordx4 v[136:139], v18, s[20:23], s26 offen offset:3072 sc1
    buffer_load_dwordx4 v[140:143], v18, s[20:23], s28 offen offset:3072 sc1
    s_waitcnt vmcnt(24)
    v_mfma_f32_32x32x16_bf16 v[176:191], v[96:99], v[144:147], v[176:191]
    v_mfma_f32_32x32x16_bf16 v[192:207], v[96:99], v[148:151], v[192:207]
    v_mfma_f32_32x32x16_bf16 v[208:223], v[100:103], v[144:147], v[208:223]
    v_mfma_f32_32x32x16_bf16 v[224:239], v[100:103], v[148:151], v[224:239]
    s_waitcnt vmcnt(20)
    v_mfma_f32_32x32x16_bf16 v[176:191], v[104:107], v[152:155], v[176:191]
    v_mfma_f32_32x32x16_bf16 v[192:207], v[104:107], v[156:159], v[192:207]
    v_mfma_f32_32x32x16_bf16 v[208:223], v[108:111], v[152:155], v[208:223]
    v_mfma_f32_32x32x16_bf16 v[224:239], v[108:111], v[156:159], v[224:239]
    s_waitcnt vmcnt(16)
    v_mfma_f32_32x32x16_bf16 v[176:191], v[24:27], v[160:163], v[176:191]
    v_mfma_f32_32x32x16_bf16 v[192:207], v[24:27], v[164:167], v[192:207]
    v_mfma_f32_32x32x16_bf16 v[208:223], v[28:31], v[160:163], v[208:223]
    v_mfma_f32_32x32x16_bf16 v[224:239], v[28:31], v[164:167], v[224:239]
    s_waitcnt vmcnt(12)
    v_mfma_f32_32x32x16_bf16 v[176:191], v[32:35], v[168:171], v[176:191]
    v_mfma_f32_32x32x16_bf16 v[192:207], v[32:35], v[172:175], v[192:207]
    v_mfma_f32_32x32x16_bf16 v[208:223], v[36:39], v[168:171], v[208:223]
    v_mfma_f32_32x32x16_bf16 v[224:239], v[36:39], v[172:175], v[224:239]
    s_waitcnt vmcnt(8)
    v_mfma_f32_32x32x16_bf16 v[176:191], v[40:43], v[112:115], v[176:191]
    v_mfma_f32_32x32x16_bf16 v[192:207], v[40:43], v[116:119], v[192:207]
    v_mfma_f32_32x32x16_bf16 v[208:223], v[44:47], v[112:115], v[208:223]
    v_mfma_f32_32x32x16_bf16 v[224:239], v[44:47], v[116:119], v[224:239]
    s_waitcnt vmcnt(4)
    v_mfma_f32_32x32x16_bf16 v[176:191], v[48:51], v[120:123], v[176:191]
    v_mfma_f32_32x32x16_bf16 v[192:207], v[48:51], v[124:127], v[192:207]
    v_mfma_f32_32x32x16_bf16 v[208:223], v[52:55], v[120:123], v[208:223]
    v_mfma_f32_32x32x16_bf16 v[224:239], v[52:55], v[124:127], v[224:239]
    s_waitcnt vmcnt(2)
    v_mfma_f32_32x32x16_bf16 v[176:191], v[56:59], v[128:131], v[176:191]
    v_mfma_f32_32x32x16_bf16 v[192:207], v[56:59], v[132:135], v[192:207]
    v_mfma_f32_32x32x16_bf16 v[208:223], v[60:63], v[128:131], v[208:223]
    v_mfma_f32_32x32x16_bf16 v[224:239], v[60:63], v[132:135], v[224:239]
    s_waitcnt vmcnt(0)
    v_mfma_f32_32x32x16_bf16 v[176:191], v[64:67], v[136:139], v[176:191]
    v_mfma_f32_32x32x16_bf16 v[192:207], v[64:67], v[140:143], v[192:207]
    v_mfma_f32_32x32x16_bf16 v[208:223], v[68:71], v[136:139], v[208:223]
    v_mfma_f32_32x32x16_bf16 v[224:239], v[68:71], v[140:143], v[224:239]
    v_and_b32 v2, 31, v1
    v_and_b32 v3, 15, v1
    v_lshrrev_b32 v4, 5, v1
    v_xor_b32 v3, v3, v4
    s_and_b32 s26, s36, 1
    s_lshl_b32 s26, s26, 14
    s_lshr_b32 s27, s36, 1
    s_lshl_b32 s27, s27, 16
    s_add_u32 s26, s26, s27
    s_add_u32 s26, s26, 32768
    v_lshlrev_b32 v2, 8, v2
    v_add_u32 v2, s26, v2
    v_xor_b32 v6, 0, v3
    v_lshl_add_u32 v12, v6, 4, v2
    v_xor_b32 v6, 2, v3
    v_lshl_add_u32 v13, v6, 4, v2
    v_xor_b32 v6, 4, v3
    v_lshl_add_u32 v14, v6, 4, v2
    v_xor_b32 v6, 6, v3
    v_lshl_add_u32 v15, v6, 4, v2
    v_xor_b32 v6, 8, v3
    v_lshl_add_u32 v16, v6, 4, v2
    v_xor_b32 v6, 10, v3
    v_lshl_add_u32 v17, v6, 4, v2
    v_xor_b32 v6, 12, v3
    v_lshl_add_u32 v18, v6, 4, v2
    v_xor_b32 v6, 14, v3
    v_lshl_add_u32 v19, v6, 4, v2
    ds_write_b128 v12, v[176:179] offset:0
    ds_write_b128 v13, v[180:183] offset:0
    ds_write_b128 v14, v[184:187] offset:0
    ds_write_b128 v15, v[188:191] offset:0
    ds_write_b128 v12, v[192:195] offset:8192
    ds_write_b128 v13, v[196:199] offset:8192
    ds_write_b128 v14, v[200:203] offset:8192
    ds_write_b128 v15, v[204:207] offset:8192
    ds_write_b128 v16, v[208:211] offset:0
    ds_write_b128 v17, v[212:215] offset:0
    ds_write_b128 v18, v[216:219] offset:0
    ds_write_b128 v19, v[220:223] offset:0
    ds_write_b128 v16, v[224:227] offset:8192
    ds_write_b128 v17, v[228:231] offset:8192
    ds_write_b128 v18, v[232:235] offset:8192
    ds_write_b128 v19, v[236:239] offset:8192
    s_waitcnt lgkmcnt(0)
    s_branch K2_FINAL
B_CONV:
    s_nop 15
    s_nop 3
    s_setprio 1
    s_lshl_b32 s39, s37, 2
    s_lshr_b32 s3, s38, 3
    s_add_u32 s39, s39, s3
    s_and_b32 s3, s38, 7
    s_mov_b32 s12, s96
    s_mov_b32 s13, s97
    s_mov_b32 s14, 0x200000
    s_mov_b32 s15, 0x00020000
    v_lshrrev_b32 v5, 3, v1
    v_lshlrev_b32 v5, 10, v5
    v_and_b32 v6, 7, v1
    v_lshl_add_u32 v5, v6, 4, v5
    s_lshl_b32 s34, s39, 16
    s_lshl_b32 s35, s36, 13
    s_add_u32 s34, s34, s35
    s_lshl_b32 s35, s3, 7
    s_add_u32 s34, s34, s35
    buffer_load_dwordx4 v[252:255], v5, s[8:11], s34 offen
    s_sub_u32 s24, s36, 4
    s_lshr_b32 s25, s24, 1
    s_and_b32 s26, s24, 1
    s_lshl_b32 s27, s2, 1
    s_add_u32 s27, s27, s25
    s_mov_b32 s31, s93
    v_and_b32 v3, 15, v1
    v_lshrrev_b32 v4, 4, v1
    v_lshlrev_b32 v7, 4, v1
    s_lshl_b32 s17, s25, 16
    s_add_u32 s18, s17, 16384
    s_lshl_b32 s16, s26, 14
    s_add_u32 s16, s16, s17
    v_lshlrev_b32 v6, 2, v1
    v_add_u32 v6, s16, v6
    ds_write_b32 v6, v160 offset:0
    ds_write_b32 v6, v161 offset:288
    ds_write_b32 v6, v162 offset:576
    ds_write_b32 v6, v163 offset:864
    ds_write_b32 v6, v164 offset:1152
    ds_write_b32 v6, v165 offset:1440
    ds_write_b32 v6, v166 offset:1728
    ds_write_b32 v6, v167 offset:2016
    ds_write_b32 v6, v168 offset:2304
    ds_write_b32 v6, v169 offset:2592
    ds_write_b32 v6, v170 offset:2880
    ds_write_b32 v6, v171 offset:3168
    ds_write_b32 v6, v172 offset:3456
    ds_write_b32 v6, v173 offset:3744
    ds_write_b32 v6, v174 offset:4032
    ds_write_b32 v6, v175 offset:4320
    ds_write_b32 v6, v176 offset:4608
    ds_write_b32 v6, v177 offset:4896
    ds_write_b32 v6, v178 offset:5184
    ds_write_b32 v6, v179 offset:5472
    ds_write_b32 v6, v180 offset:5760
    ds_write_b32 v6, v181 offset:6048
    ds_write_b32 v6, v182 offset:6336
    ds_write_b32 v6, v183 offset:6624
    ds_write_b32 v6, v184 offset:6912
    ds_write_b32 v6, v185 offset:7200
    ds_write_b32 v6, v186 offset:7488
    ds_write_b32 v6, v187 offset:7776
    ds_write_b32 v6, v188 offset:8064
    ds_write_b32 v6, v189 offset:8352
    ds_write_b32 v6, v190 offset:8640
    ds_write_b32 v6, v191 offset:8928
    ds_write_b32 v6, v192 offset:9216
    ds_write_b32 v6, v193 offset:9504
    ds_write_b32 v6, v194 offset:9792
    ds_write_b32 v6, v195 offset:10080
    ds_write_b32 v6, v196 offset:10368
    ds_write_b32 v6, v197 offset:10656
    ds_write_b32 v6, v198 offset:10944
    ds_write_b32 v6, v199 offset:11232
    ds_write_b32 v6, v200 offset:11520
    ds_write_b32 v6, v201 offset:11808
    ds_write_b32 v6, v202 offset:12096
    ds_write_b32 v6, v203 offset:12384
    ds_write_b32 v6, v204 offset:12672
    ds_write_b32 v6, v205 offset:12960
    ds_write_b32 v6, v206 offset:13248
    ds_write_b32 v6, v207 offset:13536
    ds_write_b32 v6, v208 offset:13824
    ds_write_b32 v6, v209 offset:14112
    ds_write_b32 v6, v210 offset:14400
    ds_write_b32 v6, v211 offset:14688
    ds_write_b32 v6, v212 offset:14976
    ds_write_b32 v6, v213 offset:15264
    ds_write_b32 v6, v214 offset:15552
    ds_write_b32 v6, v215 offset:15840
    ds_write_b32 v6, v216 offset:16128
    v_add_u32 v228, s17, v228
    v_add_u32 v229, s17, v229
    v_add_u32 v230, s17, v230
    v_add_u32 v231, s17, v231
    v_add_u32 v232, s17, v232
    v_add_u32 v233, s17, v233
    v_add_u32 v234, s17, v234
    v_add_u32 v235, s17, v235
    v_add_u32 v236, s17, v236
    v_add_u32 v237, s17, v237
    v_add_u32 v238, s17, v238
    v_add_u32 v239, s17, v239
    v_add_u32 v240, s17, v240
    v_add_u32 v241, s17, v241
    v_add_u32 v242, s17, v242
    v_add_u32 v243, s17, v243
    v_add_u32 v244, s17, v244
    v_mov_b32 v45, 150148
    v_mov_b32 v46, 1
    s_cmp_lg_u32 s36, 7
    s_cbranch_scc1 B_UWAIT
    v_and_b32 v48, 31, v1
    v_lshlrev_b32 v48, 2, v48
    s_lshl_b32 s28, s37, 7
    s_add_u32 s28, s28, 13370368
    v_add_u32 v48, s28, v48
    v_mov_b32 v49, 1
    s_waitcnt vmcnt(0)
    v_cmp_ne_u32 vcc, 1, v8
    s_nop 4
    s_cbranch_vccz B_UPOLL_OK
B_UPOLL:
    buffer_load_dword v47, v48, s[20:23], 0 offen sc1
    s_waitcnt vmcnt(0)
    v_and_b32 v47, v47, v49
    v_cmp_ne_u32 vcc, v47, v49
    s_nop 4
    s_cbranch_vccz B_UPOLL_OK
    s_sleep 4
    s_branch B_UPOLL
B_UPOLL_OK:
    ds_write_b32 v45, v46
    s_branch B_UGO
B_UWAIT:
    ds_read_b32 v47, v45
    s_waitcnt lgkmcnt(0)
    v_readfirstlane_b32 s92, v47
    s_nop 0
    s_cmp_eq_u32 s92, 0
    s_cbranch_scc0 B_UWAIT_OK
    s_sleep 1
    s_branch B_UWAIT
B_UWAIT_OK:
B_UGO:
    s_lshl_b32 s28, s27, 12
    s_lshl_b32 s35, s26, 11
    s_add_u32 s28, s28, s35
    s_add_u32 s29, s28, 9175040
    buffer_load_dwordx4 v[144:147], v7, s[20:23], s29 offen sc1
    buffer_load_dwordx4 v[148:151], v7, s[20:23], s29 offen offset:1024 sc1
    v_mul_u32_u24 v44, 288, v3
    v_lshl_add_u32 v44, v4, 4, v44
    v_add_u32 v44, s16, v44
    s_waitcnt lgkmcnt(0)
    ds_read_b128 v[112:115], v44 offset:11808
    ds_read_b128 v[64:67], v44 offset:0
    ds_read_b128 v[68:71], v44 offset:4608
    ds_read_b128 v[72:75], v44 offset:9216
    ds_read_b128 v[116:119], v44 offset:11872
    ds_read_b128 v[76:79], v44 offset:64
    ds_read_b128 v[80:83], v44 offset:4672
    ds_read_b128 v[84:87], v44 offset:9280
    ds_read_b128 v[120:123], v44 offset:11936
    ds_read_b128 v[88:91], v44 offset:128
    ds_read_b128 v[92:95], v44 offset:4736
    ds_read_b128 v[96:99], v44 offset:9344
    ds_read_b128 v[124:127], v44 offset:12000
    ds_read_b128 v[100:103], v44 offset:192
    ds_read_b128 v[104:107], v44 offset:4800
    ds_read_b128 v[108:111], v44 offset:9408
    s_waitcnt lgkmcnt(0)
    v_mfma_f32_16x16x32_bf16 v[128:131], v[64:67], v[112:115], 0
    v_mfma_f32_16x16x32_bf16 v[132:135], v[68:71], v[112:115], 0
    v_mfma_f32_16x16x32_bf16 v[136:139], v[72:75], v[112:115], 0
    v_mfma_f32_16x16x32_bf16 v[128:131], v[76:79], v[116:119], v[128:131]
    v_mfma_f32_16x16x32_bf16 v[132:135], v[80:83], v[116:119], v[132:135]
    v_mfma_f32_16x16x32_bf16 v[136:139], v[84:87], v[116:119], v[136:139]
    v_mfma_f32_16x16x32_bf16 v[128:131], v[88:91], v[120:123], v[128:131]
    v_mfma_f32_16x16x32_bf16 v[132:135], v[92:95], v[120:123], v[132:135]
    v_mfma_f32_16x16x32_bf16 v[136:139], v[96:99], v[120:123], v[136:139]
    v_mfma_f32_16x16x32_bf16 v[128:131], v[100:103], v[124:127], v[128:131]
    v_mfma_f32_16x16x32_bf16 v[132:135], v[104:107], v[124:127], v[132:135]
    v_mfma_f32_16x16x32_bf16 v[136:139], v[108:111], v[124:127], v[136:139]
    v_mov_b32 v45, 150080
    s_lshl_b32 s28, s25, 2
    v_add_u32 v45, s28, v45
    v_mov_b32 v46, 1
    v_mul_u32_u24 v47, 48, v1
    v_add_u32 v47, s18, v47
    s_cmp_eq_u32 s26, 0
    s_cbranch_scc1 K2_EVEN
    ds_write_b128 v47, v[128:131] offset:0
    ds_write_b128 v47, v[132:135] offset:16
    ds_write_b128 v47, v[136:139] offset:32
    s_waitcnt lgkmcnt(0)
    ds_write_b32 v45, v46
K2_SP2:
    ds_read_b32 v48, v45 offset:8
    s_waitcnt lgkmcnt(0)
    v_readfirstlane_b32 s28, v48
    s_nop 0
    s_cmp_eq_u32 s28, 0
    s_cbranch_scc1 K2_SP2
    s_branch K2_EXPAND
K2_EVEN:
    s_nop 15
    s_nop 3
K2_SP1:
    ds_read_b32 v48, v45 offset:0
    s_waitcnt lgkmcnt(0)
    v_readfirstlane_b32 s28, v48
    s_nop 0
    s_cmp_eq_u32 s28, 0
    s_cbranch_scc1 K2_SP1
    ds_read_b128 v[64:67], v47 offset:0
    ds_read_b128 v[68:71], v47 offset:16
    ds_read_b128 v[72:75], v47 offset:32
    v_lshrrev_b32 v48, 1, v4
    v_lshlrev_b32 v48, 7, v48
    v_and_b32 v49, 1, v4
    v_lshl_add_u32 v48, v49, 2, v48
    v_lshl_add_u32 v48, v3, 3, v48
    v_lshl_add_u32 v48, v48, 1, s17
    v_lshlrev_b32 v49, 6, v4
    v_add_u32 v49, 256, v49
    v_cmp_gt_u32 vcc, 2, v4
    v_lshlrev_b32 v50, 2, v3
    v_lshlrev_b32 v51, 1, v3
    v_cndmask_b32 v50, v51, v50, vcc
    v_add_u32 v49, v49, v50
    v_lshl_add_u32 v49, v49, 1, s17
    v_mov_b32 v50, 64
    v_mov_b32 v51, 4
    v_cndmask_b32 v50, v50, v51, vcc
    v_add_u32 v50, v49, v50
    v_lshlrev_b32 v51, 6, v4
    v_add_u32 v51, v51, v3
    v_add_u32 v51, 512, v51
    v_mov_b32 v52, 704
    v_cndmask_b32 v51, v52, v51, vcc
    v_cmp_eq_u32 vcc, 32, v1
    v_mov_b32 v52, 640
    s_nop 0
    v_cndmask_b32 v51, v51, v52, vcc
    v_lshl_add_u32 v51, v51, 1, s17
    s_waitcnt lgkmcnt(0)
    v_add_f32 v128, v128, v64
    v_add_f32 v129, v129, v65
    v_add_f32 v130, v130, v66
    v_add_f32 v131, v131, v67
    v_add_f32 v132, v132, v68
    v_add_f32 v133, v133, v69
    v_add_f32 v134, v134, v70
    v_add_f32 v135, v135, v71
    v_add_f32 v136, v136, v72
    v_add_f32 v137, v137, v73
    v_add_f32 v138, v138, v74
    v_add_f32 v139, v139, v75
    v_cmp_eq_u32 vcc, 0, v1
    v_mov_b32 v52, 0
    v_mov_b32 v53, s31
    v_cndmask_b32 v52, v52, v53, vcc
    v_add_f32 v128, v128, v52
    v_cvt_pk_bf16_f32 v76, v128, v129
    v_cvt_pk_bf16_f32 v77, v130, v131
    v_cvt_pk_bf16_f32 v78, v132, v133
    v_cvt_pk_bf16_f32 v79, v134, v135
    v_cvt_pk_bf16_f32 v80, v136, v137
    v_cvt_pk_bf16_f32 v81, v138, v139
    ds_write_b64 v48, v[76:77]
    ds_write_b32 v49, v78
    ds_write_b32 v50, v79
    ds_write_b16 v51, v80
    ds_write_b16_d16_hi v51, v80 offset:32
    ds_write_b16 v51, v81 offset:64
    ds_write_b16_d16_hi v51, v81 offset:96
    v_mov_b32 v52, 0
    v_mov_b32 v53, s17
    ds_write_b16 v53, v52 offset:1282
    s_waitcnt lgkmcnt(0)
    ds_write_b32 v45, v46 offset:8
K2_EXPAND:
    s_nop 15
    s_nop 3
    ds_read_u16 v88, v228
    ds_read_u16 v89, v229
    ds_read_u16 v90, v230
    ds_read_u16 v91, v231
    ds_read_u16 v92, v232
    ds_read_u16 v93, v233
    ds_read_u16 v94, v234
    ds_read_u16 v95, v235
    ds_read_u16 v96, v236
    ds_read_u16 v97, v237
    ds_read_u16 v98, v238
    ds_read_u16 v99, v239
    ds_read_u16 v100, v240
    ds_read_u16 v101, v241
    ds_read_u16 v102, v242
    ds_read_u16 v103, v243
    ds_read_u16 v104, v244
    s_lshl_b32 s28, s26, 11
    s_add_u32 s28, s28, s18
    v_lshl_add_u32 v48, v1, 5, s28
    v_mov_b32 v52, 0
    v_and_b32 v49, 15, v1
    v_lshl_add_u32 v49, v49, 2, s18
    s_waitcnt lgkmcnt(0)
    v_lshl_or_b32 v64, v89, 16, v88
    v_lshl_or_b32 v65, v91, 16, v90
    v_lshl_or_b32 v66, v93, 16, v92
    v_lshl_or_b32 v67, v95, 16, v94
    v_lshl_or_b32 v68, v97, 16, v96
    v_lshl_or_b32 v69, v99, 16, v98
    v_lshl_or_b32 v70, v101, 16, v100
    v_lshl_or_b32 v71, v103, 16, v102
    v_lshl_or_b32 v76, v90, 16, v89
    v_lshl_or_b32 v77, v92, 16, v91
    v_lshl_or_b32 v78, v94, 16, v93
    v_lshl_or_b32 v79, v96, 16, v95
    v_lshl_or_b32 v80, v98, 16, v97
    v_lshl_or_b32 v81, v100, 16, v99
    v_lshl_or_b32 v82, v102, 16, v101
    v_lshl_or_b32 v83, v104, 16, v103
    ds_write_b128 v48, v[64:67] offset:3072
    ds_write_b128 v48, v[68:71] offset:3088
    ds_write_b128 v48, v[76:79] offset:7232
    ds_write_b128 v48, v[80:83] offset:7248
    ds_write_b32 v49, v52 offset:7168
    ds_write_b32 v49, v52 offset:11328
    s_lshl_b32 s28, s25, 12
    s_lshl_b32 s35, s26, 11
    s_add_u32 s28, s28, s35
    s_add_u32 s28, s28, 131072
    v_add_u32 v49, s28, v7
    s_waitcnt vmcnt(0)
    ds_write_b128 v49, v[144:147]
    ds_write_b128 v49, v[148:151] offset:1024
    s_waitcnt lgkmcnt(0)
    v_mov_b32 v48, 150096
    s_lshl_b32 s28, s24, 2
    v_add_u32 v49, s28, v48
    s_xor_b32 s28, s28, 4
    v_add_u32 v50, s28, v48
    ds_write_b32 v49, v46
K2_SP3:
    ds_read_b32 v48, v50 offset:0
    s_waitcnt lgkmcnt(0)
    v_readfirstlane_b32 s28, v48
    s_nop 0
    s_cmp_eq_u32 s28, 0
    s_cbranch_scc1 K2_SP3
    v_lshlrev_b32 v48, 3, v4
    v_sub_u32 v48, v48, v3
    v_add_u32 v48, 2047, v48
    v_and_b32 v48, -2, v48
    v_lshlrev_b32 v48, 1, v48
    v_and_b32 v49, 1, v3
    v_xor_b32 v49, 1, v49
    v_mul_u32_u24 v49, 4160, v49
    v_add_u32 v48, v48, v49
    s_add_u32 s28, s18, 3072
    s_lshl_b32 s29, s26, 5
    s_sub_u32 s28, s28, s29
    v_add_u32 v48, s28, v48
    v_subrev_u32 v52, 960, v48
    v_subrev_u32 v53, 1984, v48
    v_subrev_u32 v54, 3008, v48
    v_subrev_u32 v55, 4032, v48
    v_mov_b32 v112, 0
    v_mov_b32 v113, 0
    v_mov_b32 v114, 0
    v_mov_b32 v115, 0
    v_mov_b32 v116, 0
    v_mov_b32 v117, 0
    v_mov_b32 v118, 0
    v_mov_b32 v119, 0
    v_mov_b32 v120, 0
    v_mov_b32 v121, 0
    v_mov_b32 v122, 0
    v_mov_b32 v123, 0
    v_mov_b32 v124, 0
    v_mov_b32 v125, 0
    v_mov_b32 v126, 0
    v_mov_b32 v127, 0
    v_lshlrev_b32 v49, 8, v3
    v_lshl_add_u32 v49, v4, 4, v49
    s_lshl_b32 s28, s25, 12
    s_add_u32 s28, s28, 131072
    v_add_u32 v49, s28, v49
    ds_read_b128 v[200:203], v49 offset:0
    ds_read_b128 v[204:207], v49 offset:64
    ds_read_b128 v[208:211], v49 offset:128
    ds_read_b128 v[212:215], v49 offset:192
    ds_read2_b32 v[64:65], v52 offset0:240 offset1:241
    ds_read2_b32 v[66:67], v52 offset0:242 offset1:243
    ds_read2_b32 v[68:69], v52 offset0:224 offset1:225
    ds_read2_b32 v[70:71], v52 offset0:226 offset1:227
    ds_read2_b32 v[72:73], v52 offset0:208 offset1:209
    ds_read2_b32 v[74:75], v52 offset0:210 offset1:211
    ds_read2_b32 v[76:77], v52 offset0:192 offset1:193
    ds_read2_b32 v[78:79], v52 offset0:194 offset1:195
    s_waitcnt lgkmcnt(0)
    ds_read2_b32 v[80:81], v52 offset0:176 offset1:177
    ds_read2_b32 v[82:83], v52 offset0:178 offset1:179
    ds_read2_b32 v[84:85], v52 offset0:160 offset1:161
    ds_read2_b32 v[86:87], v52 offset0:162 offset1:163
    ds_read2_b32 v[88:89], v52 offset0:144 offset1:145
    ds_read2_b32 v[90:91], v52 offset0:146 offset1:147
    ds_read2_b32 v[92:93], v52 offset0:128 offset1:129
    ds_read2_b32 v[94:95], v52 offset0:130 offset1:131
    v_mfma_f32_16x16x32_bf16 v[124:127], v[64:67], v[212:215], v[124:127]
    v_mov_b32_dpp v212, v212 row_shr:1 row_mask:0xf bank_mask:0xf bound_ctrl:0
    v_mov_b32_dpp v213, v213 row_shr:1 row_mask:0xf bank_mask:0xf bound_ctrl:0
    v_mov_b32_dpp v214, v214 row_shr:1 row_mask:0xf bank_mask:0xf bound_ctrl:0
    v_mov_b32_dpp v215, v215 row_shr:1 row_mask:0xf bank_mask:0xf bound_ctrl:0
    v_mfma_f32_16x16x32_bf16 v[120:123], v[64:67], v[208:211], v[120:123]
    v_mfma_f32_16x16x32_bf16 v[124:127], v[68:71], v[208:211], v[124:127]
    v_mov_b32_dpp v208, v208 row_shr:1 row_mask:0xf bank_mask:0xf bound_ctrl:0
    v_mov_b32_dpp v209, v209 row_shr:1 row_mask:0xf bank_mask:0xf bound_ctrl:0
    v_mov_b32_dpp v210, v210 row_shr:1 row_mask:0xf bank_mask:0xf bound_ctrl:0
    v_mov_b32_dpp v211, v211 row_shr:1 row_mask:0xf bank_mask:0xf bound_ctrl:0
    v_mfma_f32_16x16x32_bf16 v[116:119], v[64:67], v[204:207], v[116:119]
    v_mfma_f32_16x16x32_bf16 v[120:123], v[68:71], v[204:207], v[120:123]
    v_mfma_f32_16x16x32_bf16 v[124:127], v[72:75], v[204:207], v[124:127]
    v_mov_b32_dpp v204, v204 row_shr:1 row_mask:0xf bank_mask:0xf bound_ctrl:0
    v_mov_b32_dpp v205, v205 row_shr:1 row_mask:0xf bank_mask:0xf bound_ctrl:0
    v_mov_b32_dpp v206, v206 row_shr:1 row_mask:0xf bank_mask:0xf bound_ctrl:0
    v_mov_b32_dpp v207, v207 row_shr:1 row_mask:0xf bank_mask:0xf bound_ctrl:0
    v_mfma_f32_16x16x32_bf16 v[112:115], v[64:67], v[200:203], v[112:115]
    v_mfma_f32_16x16x32_bf16 v[116:119], v[68:71], v[200:203], v[116:119]
    v_mfma_f32_16x16x32_bf16 v[120:123], v[72:75], v[200:203], v[120:123]
    v_mfma_f32_16x16x32_bf16 v[124:127], v[76:79], v[200:203], v[124:127]
    v_mov_b32_dpp v200, v200 row_shr:1 row_mask:0xf bank_mask:0xf bound_ctrl:0
    v_mov_b32_dpp v201, v201 row_shr:1 row_mask:0xf bank_mask:0xf bound_ctrl:0
    v_mov_b32_dpp v202, v202 row_shr:1 row_mask:0xf bank_mask:0xf bound_ctrl:0
    v_mov_b32_dpp v203, v203 row_shr:1 row_mask:0xf bank_mask:0xf bound_ctrl:0
    s_waitcnt lgkmcnt(0)
    ds_read2_b32 v[96:97], v52 offset0:112 offset1:113
    ds_read2_b32 v[98:99], v52 offset0:114 offset1:115
    ds_read2_b32 v[100:101], v52 offset0:96 offset1:97
    ds_read2_b32 v[102:103], v52 offset0:98 offset1:99
    ds_read2_b32 v[104:105], v52 offset0:80 offset1:81
    ds_read2_b32 v[106:107], v52 offset0:82 offset1:83
    ds_read2_b32 v[108:109], v52 offset0:64 offset1:65
    ds_read2_b32 v[110:111], v52 offset0:66 offset1:67
    v_mfma_f32_16x16x32_bf16 v[112:115], v[68:71], v[212:215], v[112:115]
    v_mfma_f32_16x16x32_bf16 v[116:119], v[72:75], v[212:215], v[116:119]
    v_mfma_f32_16x16x32_bf16 v[120:123], v[76:79], v[212:215], v[120:123]
    v_mfma_f32_16x16x32_bf16 v[124:127], v[80:83], v[212:215], v[124:127]
    v_mov_b32_dpp v212, v212 row_shr:1 row_mask:0xf bank_mask:0xf bound_ctrl:0
    v_mov_b32_dpp v213, v213 row_shr:1 row_mask:0xf bank_mask:0xf bound_ctrl:0
    v_mov_b32_dpp v214, v214 row_shr:1 row_mask:0xf bank_mask:0xf bound_ctrl:0
    v_mov_b32_dpp v215, v215 row_shr:1 row_mask:0xf bank_mask:0xf bound_ctrl:0
    v_mfma_f32_16x16x32_bf16 v[112:115], v[72:75], v[208:211], v[112:115]
    v_mfma_f32_16x16x32_bf16 v[116:119], v[76:79], v[208:211], v[116:119]
    v_mfma_f32_16x16x32_bf16 v[120:123], v[80:83], v[208:211], v[120:123]
    v_mfma_f32_16x16x32_bf16 v[124:127], v[84:87], v[208:211], v[124:127]
    v_mov_b32_dpp v208, v208 row_shr:1 row_mask:0xf bank_mask:0xf bound_ctrl:0
    v_mov_b32_dpp v209, v209 row_shr:1 row_mask:0xf bank_mask:0xf bound_ctrl:0
    v_mov_b32_dpp v210, v210 row_shr:1 row_mask:0xf bank_mask:0xf bound_ctrl:0
    v_mov_b32_dpp v211, v211 row_shr:1 row_mask:0xf bank_mask:0xf bound_ctrl:0
    v_mfma_f32_16x16x32_bf16 v[112:115], v[76:79], v[204:207], v[112:115]
    v_mfma_f32_16x16x32_bf16 v[116:119], v[80:83], v[204:207], v[116:119]
    v_mfma_f32_16x16x32_bf16 v[120:123], v[84:87], v[204:207], v[120:123]
    v_mfma_f32_16x16x32_bf16 v[124:127], v[88:91], v[204:207], v[124:127]
    v_mov_b32_dpp v204, v204 row_shr:1 row_mask:0xf bank_mask:0xf bound_ctrl:0
    v_mov_b32_dpp v205, v205 row_shr:1 row_mask:0xf bank_mask:0xf bound_ctrl:0
    v_mov_b32_dpp v206, v206 row_shr:1 row_mask:0xf bank_mask:0xf bound_ctrl:0
    v_mov_b32_dpp v207, v207 row_shr:1 row_mask:0xf bank_mask:0xf bound_ctrl:0
    v_mfma_f32_16x16x32_bf16 v[112:115], v[80:83], v[200:203], v[112:115]
    v_mfma_f32_16x16x32_bf16 v[116:119], v[84:87], v[200:203], v[116:119]
    v_mfma_f32_16x16x32_bf16 v[120:123], v[88:91], v[200:203], v[120:123]
    v_mfma_f32_16x16x32_bf16 v[124:127], v[92:95], v[200:203], v[124:127]
    v_mov_b32_dpp v200, v200 row_shr:1 row_mask:0xf bank_mask:0xf bound_ctrl:0
    v_mov_b32_dpp v201, v201 row_shr:1 row_mask:0xf bank_mask:0xf bound_ctrl:0
    v_mov_b32_dpp v202, v202 row_shr:1 row_mask:0xf bank_mask:0xf bound_ctrl:0
    v_mov_b32_dpp v203, v203 row_shr:1 row_mask:0xf bank_mask:0xf bound_ctrl:0
    s_waitcnt lgkmcnt(0)
    ds_read2_b32 v[64:65], v52 offset0:48 offset1:49
    ds_read2_b32 v[66:67], v52 offset0:50 offset1:51
    ds_read2_b32 v[68:69], v52 offset0:32 offset1:33
    ds_read2_b32 v[70:71], v52 offset0:34 offset1:35
    ds_read2_b32 v[72:73], v52 offset0:16 offset1:17
    ds_read2_b32 v[74:75], v52 offset0:18 offset1:19
    ds_read2_b32 v[76:77], v52 offset0:0 offset1:1
    ds_read2_b32 v[78:79], v52 offset0:2 offset1:3
    v_mfma_f32_16x16x32_bf16 v[112:115], v[84:87], v[212:215], v[112:115]
    v_mfma_f32_16x16x32_bf16 v[116:119], v[88:91], v[212:215], v[116:119]
    v_mfma_f32_16x16x32_bf16 v[120:123], v[92:95], v[212:215], v[120:123]
    v_mfma_f32_16x16x32_bf16 v[124:127], v[96:99], v[212:215], v[124:127]
    v_mov_b32_dpp v212, v212 row_shr:1 row_mask:0xf bank_mask:0xf bound_ctrl:0
    v_mov_b32_dpp v213, v213 row_shr:1 row_mask:0xf bank_mask:0xf bound_ctrl:0
    v_mov_b32_dpp v214, v214 row_shr:1 row_mask:0xf bank_mask:0xf bound_ctrl:0
    v_mov_b32_dpp v215, v215 row_shr:1 row_mask:0xf bank_mask:0xf bound_ctrl:0
    v_mfma_f32_16x16x32_bf16 v[112:115], v[88:91], v[208:211], v[112:115]
    v_mfma_f32_16x16x32_bf16 v[116:119], v[92:95], v[208:211], v[116:119]
    v_mfma_f32_16x16x32_bf16 v[120:123], v[96:99], v[208:211], v[120:123]
    v_mfma_f32_16x16x32_bf16 v[124:127], v[100:103], v[208:211], v[124:127]
    v_mov_b32_dpp v208, v208 row_shr:1 row_mask:0xf bank_mask:0xf bound_ctrl:0
    v_mov_b32_dpp v209, v209 row_shr:1 row_mask:0xf bank_mask:0xf bound_ctrl:0
    v_mov_b32_dpp v210, v210 row_shr:1 row_mask:0xf bank_mask:0xf bound_ctrl:0
    v_mov_b32_dpp v211, v211 row_shr:1 row_mask:0xf bank_mask:0xf bound_ctrl:0
    v_mfma_f32_16x16x32_bf16 v[112:115], v[92:95], v[204:207], v[112:115]
    v_mfma_f32_16x16x32_bf16 v[116:119], v[96:99], v[204:207], v[116:119]
    v_mfma_f32_16x16x32_bf16 v[120:123], v[100:103], v[204:207], v[120:123]
    v_mfma_f32_16x16x32_bf16 v[124:127], v[104:107], v[204:207], v[124:127]
    v_mov_b32_dpp v204, v204 row_shr:1 row_mask:0xf bank_mask:0xf bound_ctrl:0
    v_mov_b32_dpp v205, v205 row_shr:1 row_mask:0xf bank_mask:0xf bound_ctrl:0
    v_mov_b32_dpp v206, v206 row_shr:1 row_mask:0xf bank_mask:0xf bound_ctrl:0
    v_mov_b32_dpp v207, v207 row_shr:1 row_mask:0xf bank_mask:0xf bound_ctrl:0
    v_mfma_f32_16x16x32_bf16 v[112:115], v[96:99], v[200:203], v[112:115]
    v_mfma_f32_16x16x32_bf16 v[116:119], v[100:103], v[200:203], v[116:119]
    v_mfma_f32_16x16x32_bf16 v[120:123], v[104:107], v[200:203], v[120:123]
    v_mfma_f32_16x16x32_bf16 v[124:127], v[108:111], v[200:203], v[124:127]
    v_mov_b32_dpp v200, v200 row_shr:1 row_mask:0xf bank_mask:0xf bound_ctrl:0
    v_mov_b32_dpp v201, v201 row_shr:1 row_mask:0xf bank_mask:0xf bound_ctrl:0
    v_mov_b32_dpp v202, v202 row_shr:1 row_mask:0xf bank_mask:0xf bound_ctrl:0
    v_mov_b32_dpp v203, v203 row_shr:1 row_mask:0xf bank_mask:0xf bound_ctrl:0
    s_waitcnt lgkmcnt(0)
    ds_read2_b32 v[80:81], v53 offset0:240 offset1:241
    ds_read2_b32 v[82:83], v53 offset0:242 offset1:243
    ds_read2_b32 v[84:85], v53 offset0:224 offset1:225
    ds_read2_b32 v[86:87], v53 offset0:226 offset1:227
    ds_read2_b32 v[88:89], v53 offset0:208 offset1:209
    ds_read2_b32 v[90:91], v53 offset0:210 offset1:211
    ds_read2_b32 v[92:93], v53 offset0:192 offset1:193
    ds_read2_b32 v[94:95], v53 offset0:194 offset1:195
    v_mfma_f32_16x16x32_bf16 v[112:115], v[100:103], v[212:215], v[112:115]
    v_mfma_f32_16x16x32_bf16 v[116:119], v[104:107], v[212:215], v[116:119]
    v_mfma_f32_16x16x32_bf16 v[120:123], v[108:111], v[212:215], v[120:123]
    v_mfma_f32_16x16x32_bf16 v[124:127], v[64:67], v[212:215], v[124:127]
    v_mov_b32_dpp v212, v212 row_shr:1 row_mask:0xf bank_mask:0xf bound_ctrl:0
    v_mov_b32_dpp v213, v213 row_shr:1 row_mask:0xf bank_mask:0xf bound_ctrl:0
    v_mov_b32_dpp v214, v214 row_shr:1 row_mask:0xf bank_mask:0xf bound_ctrl:0
    v_mov_b32_dpp v215, v215 row_shr:1 row_mask:0xf bank_mask:0xf bound_ctrl:0
    v_mfma_f32_16x16x32_bf16 v[112:115], v[104:107], v[208:211], v[112:115]
    v_mfma_f32_16x16x32_bf16 v[116:119], v[108:111], v[208:211], v[116:119]
    v_mfma_f32_16x16x32_bf16 v[120:123], v[64:67], v[208:211], v[120:123]
    v_mfma_f32_16x16x32_bf16 v[124:127], v[68:71], v[208:211], v[124:127]
    v_mov_b32_dpp v208, v208 row_shr:1 row_mask:0xf bank_mask:0xf bound_ctrl:0
    v_mov_b32_dpp v209, v209 row_shr:1 row_mask:0xf bank_mask:0xf bound_ctrl:0
    v_mov_b32_dpp v210, v210 row_shr:1 row_mask:0xf bank_mask:0xf bound_ctrl:0
    v_mov_b32_dpp v211, v211 row_shr:1 row_mask:0xf bank_mask:0xf bound_ctrl:0
    v_mfma_f32_16x16x32_bf16 v[112:115], v[108:111], v[204:207], v[112:115]
    v_mfma_f32_16x16x32_bf16 v[116:119], v[64:67], v[204:207], v[116:119]
    v_mfma_f32_16x16x32_bf16 v[120:123], v[68:71], v[204:207], v[120:123]
    v_mfma_f32_16x16x32_bf16 v[124:127], v[72:75], v[204:207], v[124:127]
    v_mov_b32_dpp v204, v204 row_shr:1 row_mask:0xf bank_mask:0xf bound_ctrl:0
    v_mov_b32_dpp v205, v205 row_shr:1 row_mask:0xf bank_mask:0xf bound_ctrl:0
    v_mov_b32_dpp v206, v206 row_shr:1 row_mask:0xf bank_mask:0xf bound_ctrl:0
    v_mov_b32_dpp v207, v207 row_shr:1 row_mask:0xf bank_mask:0xf bound_ctrl:0
    v_mfma_f32_16x16x32_bf16 v[112:115], v[64:67], v[200:203], v[112:115]
    v_mfma_f32_16x16x32_bf16 v[116:119], v[68:71], v[200:203], v[116:119]
    v_mfma_f32_16x16x32_bf16 v[120:123], v[72:75], v[200:203], v[120:123]
    v_mfma_f32_16x16x32_bf16 v[124:127], v[76:79], v[200:203], v[124:127]
    v_mov_b32_dpp v200, v200 row_shr:1 row_mask:0xf bank_mask:0xf bound_ctrl:0
    v_mov_b32_dpp v201, v201 row_shr:1 row_mask:0xf bank_mask:0xf bound_ctrl:0
    v_mov_b32_dpp v202, v202 row_shr:1 row_mask:0xf bank_mask:0xf bound_ctrl:0
    v_mov_b32_dpp v203, v203 row_shr:1 row_mask:0xf bank_mask:0xf bound_ctrl:0
    s_waitcnt lgkmcnt(0)
    ds_read2_b32 v[96:97], v53 offset0:176 offset1:177
    ds_read2_b32 v[98:99], v53 offset0:178 offset1:179
    ds_read2_b32 v[100:101], v53 offset0:160 offset1:161
    ds_read2_b32 v[102:103], v53 offset0:162 offset1:163
    ds_read2_b32 v[104:105], v53 offset0:144 offset1:145
    ds_read2_b32 v[106:107], v53 offset0:146 offset1:147
    ds_read2_b32 v[108:109], v53 offset0:128 offset1:129
    ds_read2_b32 v[110:111], v53 offset0:130 offset1:131
    v_mfma_f32_16x16x32_bf16 v[112:115], v[68:71], v[212:215], v[112:115]
    v_mfma_f32_16x16x32_bf16 v[116:119], v[72:75], v[212:215], v[116:119]
    v_mfma_f32_16x16x32_bf16 v[120:123], v[76:79], v[212:215], v[120:123]
    v_mfma_f32_16x16x32_bf16 v[124:127], v[80:83], v[212:215], v[124:127]
    v_mov_b32_dpp v212, v212 row_shr:1 row_mask:0xf bank_mask:0xf bound_ctrl:0
    v_mov_b32_dpp v213, v213 row_shr:1 row_mask:0xf bank_mask:0xf bound_ctrl:0
    v_mov_b32_dpp v214, v214 row_shr:1 row_mask:0xf bank_mask:0xf bound_ctrl:0
    v_mov_b32_dpp v215, v215 row_shr:1 row_mask:0xf bank_mask:0xf bound_ctrl:0
    v_mfma_f32_16x16x32_bf16 v[112:115], v[72:75], v[208:211], v[112:115]
    v_mfma_f32_16x16x32_bf16 v[116:119], v[76:79], v[208:211], v[116:119]
    v_mfma_f32_16x16x32_bf16 v[120:123], v[80:83], v[208:211], v[120:123]
    v_mfma_f32_16x16x32_bf16 v[124:127], v[84:87], v[208:211], v[124:127]
    v_mov_b32_dpp v208, v208 row_shr:1 row_mask:0xf bank_mask:0xf bound_ctrl:0
    v_mov_b32_dpp v209, v209 row_shr:1 row_mask:0xf bank_mask:0xf bound_ctrl:0
    v_mov_b32_dpp v210, v210 row_shr:1 row_mask:0xf bank_mask:0xf bound_ctrl:0
    v_mov_b32_dpp v211, v211 row_shr:1 row_mask:0xf bank_mask:0xf bound_ctrl:0
    v_mfma_f32_16x16x32_bf16 v[112:115], v[76:79], v[204:207], v[112:115]
    v_mfma_f32_16x16x32_bf16 v[116:119], v[80:83], v[204:207], v[116:119]
    v_mfma_f32_16x16x32_bf16 v[120:123], v[84:87], v[204:207], v[120:123]
    v_mfma_f32_16x16x32_bf16 v[124:127], v[88:91], v[204:207], v[124:127]
    v_mov_b32_dpp v204, v204 row_shr:1 row_mask:0xf bank_mask:0xf bound_ctrl:0
    v_mov_b32_dpp v205, v205 row_shr:1 row_mask:0xf bank_mask:0xf bound_ctrl:0
    v_mov_b32_dpp v206, v206 row_shr:1 row_mask:0xf bank_mask:0xf bound_ctrl:0
    v_mov_b32_dpp v207, v207 row_shr:1 row_mask:0xf bank_mask:0xf bound_ctrl:0
    v_mfma_f32_16x16x32_bf16 v[112:115], v[80:83], v[200:203], v[112:115]
    v_mfma_f32_16x16x32_bf16 v[116:119], v[84:87], v[200:203], v[116:119]
    v_mfma_f32_16x16x32_bf16 v[120:123], v[88:91], v[200:203], v[120:123]
    v_mfma_f32_16x16x32_bf16 v[124:127], v[92:95], v[200:203], v[124:127]
    v_mov_b32_dpp v200, v200 row_shr:1 row_mask:0xf bank_mask:0xf bound_ctrl:0
    v_mov_b32_dpp v201, v201 row_shr:1 row_mask:0xf bank_mask:0xf bound_ctrl:0
    v_mov_b32_dpp v202, v202 row_shr:1 row_mask:0xf bank_mask:0xf bound_ctrl:0
    v_mov_b32_dpp v203, v203 row_shr:1 row_mask:0xf bank_mask:0xf bound_ctrl:0
    s_waitcnt lgkmcnt(0)
    ds_read2_b32 v[64:65], v53 offset0:112 offset1:113
    ds_read2_b32 v[66:67], v53 offset0:114 offset1:115
    ds_read2_b32 v[68:69], v53 offset0:96 offset1:97
    ds_read2_b32 v[70:71], v53 offset0:98 offset1:99
    ds_read2_b32 v[72:73], v53 offset0:80 offset1:81
    ds_read2_b32 v[74:75], v53 offset0:82 offset1:83
    ds_read2_b32 v[76:77], v53 offset0:64 offset1:65
    ds_read2_b32 v[78:79], v53 offset0:66 offset1:67
    v_mfma_f32_16x16x32_bf16 v[112:115], v[84:87], v[212:215], v[112:115]
    v_mfma_f32_16x16x32_bf16 v[116:119], v[88:91], v[212:215], v[116:119]
    v_mfma_f32_16x16x32_bf16 v[120:123], v[92:95], v[212:215], v[120:123]
    v_mfma_f32_16x16x32_bf16 v[124:127], v[96:99], v[212:215], v[124:127]
    v_mov_b32_dpp v212, v212 row_shr:1 row_mask:0xf bank_mask:0xf bound_ctrl:0
    v_mov_b32_dpp v213, v213 row_shr:1 row_mask:0xf bank_mask:0xf bound_ctrl:0
    v_mov_b32_dpp v214, v214 row_shr:1 row_mask:0xf bank_mask:0xf bound_ctrl:0
    v_mov_b32_dpp v215, v215 row_shr:1 row_mask:0xf bank_mask:0xf bound_ctrl:0
    v_mfma_f32_16x16x32_bf16 v[112:115], v[88:91], v[208:211], v[112:115]
    v_mfma_f32_16x16x32_bf16 v[116:119], v[92:95], v[208:211], v[116:119]
    v_mfma_f32_16x16x32_bf16 v[120:123], v[96:99], v[208:211], v[120:123]
    v_mfma_f32_16x16x32_bf16 v[124:127], v[100:103], v[208:211], v[124:127]
    v_mov_b32_dpp v208, v208 row_shr:1 row_mask:0xf bank_mask:0xf bound_ctrl:0
    v_mov_b32_dpp v209, v209 row_shr:1 row_mask:0xf bank_mask:0xf bound_ctrl:0
    v_mov_b32_dpp v210, v210 row_shr:1 row_mask:0xf bank_mask:0xf bound_ctrl:0
    v_mov_b32_dpp v211, v211 row_shr:1 row_mask:0xf bank_mask:0xf bound_ctrl:0
    v_mfma_f32_16x16x32_bf16 v[112:115], v[92:95], v[204:207], v[112:115]
    v_mfma_f32_16x16x32_bf16 v[116:119], v[96:99], v[204:207], v[116:119]
    v_mfma_f32_16x16x32_bf16 v[120:123], v[100:103], v[204:207], v[120:123]
    v_mfma_f32_16x16x32_bf16 v[124:127], v[104:107], v[204:207], v[124:127]
    v_mov_b32_dpp v204, v204 row_shr:1 row_mask:0xf bank_mask:0xf bound_ctrl:0
    v_mov_b32_dpp v205, v205 row_shr:1 row_mask:0xf bank_mask:0xf bound_ctrl:0
    v_mov_b32_dpp v206, v206 row_shr:1 row_mask:0xf bank_mask:0xf bound_ctrl:0
    v_mov_b32_dpp v207, v207 row_shr:1 row_mask:0xf bank_mask:0xf bound_ctrl:0
    v_mfma_f32_16x16x32_bf16 v[112:115], v[96:99], v[200:203], v[112:115]
    v_mfma_f32_16x16x32_bf16 v[116:119], v[100:103], v[200:203], v[116:119]
    v_mfma_f32_16x16x32_bf16 v[120:123], v[104:107], v[200:203], v[120:123]
    v_mfma_f32_16x16x32_bf16 v[124:127], v[108:111], v[200:203], v[124:127]
    v_mov_b32_dpp v200, v200 row_shr:1 row_mask:0xf bank_mask:0xf bound_ctrl:0
    v_mov_b32_dpp v201, v201 row_shr:1 row_mask:0xf bank_mask:0xf bound_ctrl:0
    v_mov_b32_dpp v202, v202 row_shr:1 row_mask:0xf bank_mask:0xf bound_ctrl:0
    v_mov_b32_dpp v203, v203 row_shr:1 row_mask:0xf bank_mask:0xf bound_ctrl:0
    s_waitcnt lgkmcnt(0)
    ds_read2_b32 v[80:81], v53 offset0:48 offset1:49
    ds_read2_b32 v[82:83], v53 offset0:50 offset1:51
    ds_read2_b32 v[84:85], v53 offset0:32 offset1:33
    ds_read2_b32 v[86:87], v53 offset0:34 offset1:35
    ds_read2_b32 v[88:89], v53 offset0:16 offset1:17
    ds_read2_b32 v[90:91], v53 offset0:18 offset1:19
    ds_read2_b32 v[92:93], v53 offset0:0 offset1:1
    ds_read2_b32 v[94:95], v53 offset0:2 offset1:3
    v_mfma_f32_16x16x32_bf16 v[112:115], v[100:103], v[212:215], v[112:115]
    v_mfma_f32_16x16x32_bf16 v[116:119], v[104:107], v[212:215], v[116:119]
    v_mfma_f32_16x16x32_bf16 v[120:123], v[108:111], v[212:215], v[120:123]
    v_mfma_f32_16x16x32_bf16 v[124:127], v[64:67], v[212:215], v[124:127]
    v_mov_b32_dpp v212, v212 row_shr:1 row_mask:0xf bank_mask:0xf bound_ctrl:0
    v_mov_b32_dpp v213, v213 row_shr:1 row_mask:0xf bank_mask:0xf bound_ctrl:0
    v_mov_b32_dpp v214, v214 row_shr:1 row_mask:0xf bank_mask:0xf bound_ctrl:0
    v_mov_b32_dpp v215, v215 row_shr:1 row_mask:0xf bank_mask:0xf bound_ctrl:0
    v_mfma_f32_16x16x32_bf16 v[112:115], v[104:107], v[208:211], v[112:115]
    v_mfma_f32_16x16x32_bf16 v[116:119], v[108:111], v[208:211], v[116:119]
    v_mfma_f32_16x16x32_bf16 v[120:123], v[64:67], v[208:211], v[120:123]
    v_mfma_f32_16x16x32_bf16 v[124:127], v[68:71], v[208:211], v[124:127]
    v_mov_b32_dpp v208, v208 row_shr:1 row_mask:0xf bank_mask:0xf bound_ctrl:0
    v_mov_b32_dpp v209, v209 row_shr:1 row_mask:0xf bank_mask:0xf bound_ctrl:0
    v_mov_b32_dpp v210, v210 row_shr:1 row_mask:0xf bank_mask:0xf bound_ctrl:0
    v_mov_b32_dpp v211, v211 row_shr:1 row_mask:0xf bank_mask:0xf bound_ctrl:0
    v_mfma_f32_16x16x32_bf16 v[112:115], v[108:111], v[204:207], v[112:115]
    v_mfma_f32_16x16x32_bf16 v[116:119], v[64:67], v[204:207], v[116:119]
    v_mfma_f32_16x16x32_bf16 v[120:123], v[68:71], v[204:207], v[120:123]
    v_mfma_f32_16x16x32_bf16 v[124:127], v[72:75], v[204:207], v[124:127]
    v_mov_b32_dpp v204, v204 row_shr:1 row_mask:0xf bank_mask:0xf bound_ctrl:0
    v_mov_b32_dpp v205, v205 row_shr:1 row_mask:0xf bank_mask:0xf bound_ctrl:0
    v_mov_b32_dpp v206, v206 row_shr:1 row_mask:0xf bank_mask:0xf bound_ctrl:0
    v_mov_b32_dpp v207, v207 row_shr:1 row_mask:0xf bank_mask:0xf bound_ctrl:0
    v_mfma_f32_16x16x32_bf16 v[112:115], v[64:67], v[200:203], v[112:115]
    v_mfma_f32_16x16x32_bf16 v[116:119], v[68:71], v[200:203], v[116:119]
    v_mfma_f32_16x16x32_bf16 v[120:123], v[72:75], v[200:203], v[120:123]
    v_mfma_f32_16x16x32_bf16 v[124:127], v[76:79], v[200:203], v[124:127]
    v_mov_b32_dpp v200, v200 row_shr:1 row_mask:0xf bank_mask:0xf bound_ctrl:0
    v_mov_b32_dpp v201, v201 row_shr:1 row_mask:0xf bank_mask:0xf bound_ctrl:0
    v_mov_b32_dpp v202, v202 row_shr:1 row_mask:0xf bank_mask:0xf bound_ctrl:0
    v_mov_b32_dpp v203, v203 row_shr:1 row_mask:0xf bank_mask:0xf bound_ctrl:0
    s_waitcnt lgkmcnt(0)
    ds_read2_b32 v[96:97], v54 offset0:240 offset1:241
    ds_read2_b32 v[98:99], v54 offset0:242 offset1:243
    ds_read2_b32 v[100:101], v54 offset0:224 offset1:225
    ds_read2_b32 v[102:103], v54 offset0:226 offset1:227
    ds_read2_b32 v[104:105], v54 offset0:208 offset1:209
    ds_read2_b32 v[106:107], v54 offset0:210 offset1:211
    ds_read2_b32 v[108:109], v54 offset0:192 offset1:193
    ds_read2_b32 v[110:111], v54 offset0:194 offset1:195
    v_mfma_f32_16x16x32_bf16 v[112:115], v[68:71], v[212:215], v[112:115]
    v_mfma_f32_16x16x32_bf16 v[116:119], v[72:75], v[212:215], v[116:119]
    v_mfma_f32_16x16x32_bf16 v[120:123], v[76:79], v[212:215], v[120:123]
    v_mfma_f32_16x16x32_bf16 v[124:127], v[80:83], v[212:215], v[124:127]
    v_mov_b32_dpp v212, v212 row_shr:1 row_mask:0xf bank_mask:0xf bound_ctrl:0
    v_mov_b32_dpp v213, v213 row_shr:1 row_mask:0xf bank_mask:0xf bound_ctrl:0
    v_mov_b32_dpp v214, v214 row_shr:1 row_mask:0xf bank_mask:0xf bound_ctrl:0
    v_mov_b32_dpp v215, v215 row_shr:1 row_mask:0xf bank_mask:0xf bound_ctrl:0
    v_mfma_f32_16x16x32_bf16 v[112:115], v[72:75], v[208:211], v[112:115]
    v_mfma_f32_16x16x32_bf16 v[116:119], v[76:79], v[208:211], v[116:119]
    v_mfma_f32_16x16x32_bf16 v[120:123], v[80:83], v[208:211], v[120:123]
    v_mfma_f32_16x16x32_bf16 v[124:127], v[84:87], v[208:211], v[124:127]
    v_mov_b32_dpp v208, v208 row_shr:1 row_mask:0xf bank_mask:0xf bound_ctrl:0
    v_mov_b32_dpp v209, v209 row_shr:1 row_mask:0xf bank_mask:0xf bound_ctrl:0
    v_mov_b32_dpp v210, v210 row_shr:1 row_mask:0xf bank_mask:0xf bound_ctrl:0
    v_mov_b32_dpp v211, v211 row_shr:1 row_mask:0xf bank_mask:0xf bound_ctrl:0
    v_mfma_f32_16x16x32_bf16 v[112:115], v[76:79], v[204:207], v[112:115]
    v_mfma_f32_16x16x32_bf16 v[116:119], v[80:83], v[204:207], v[116:119]
    v_mfma_f32_16x16x32_bf16 v[120:123], v[84:87], v[204:207], v[120:123]
    v_mfma_f32_16x16x32_bf16 v[124:127], v[88:91], v[204:207], v[124:127]
    v_mov_b32_dpp v204, v204 row_shr:1 row_mask:0xf bank_mask:0xf bound_ctrl:0
    v_mov_b32_dpp v205, v205 row_shr:1 row_mask:0xf bank_mask:0xf bound_ctrl:0
    v_mov_b32_dpp v206, v206 row_shr:1 row_mask:0xf bank_mask:0xf bound_ctrl:0
    v_mov_b32_dpp v207, v207 row_shr:1 row_mask:0xf bank_mask:0xf bound_ctrl:0
    v_mfma_f32_16x16x32_bf16 v[112:115], v[80:83], v[200:203], v[112:115]
    v_mfma_f32_16x16x32_bf16 v[116:119], v[84:87], v[200:203], v[116:119]
    v_mfma_f32_16x16x32_bf16 v[120:123], v[88:91], v[200:203], v[120:123]
    v_mfma_f32_16x16x32_bf16 v[124:127], v[92:95], v[200:203], v[124:127]
    v_mov_b32_dpp v200, v200 row_shr:1 row_mask:0xf bank_mask:0xf bound_ctrl:0
    v_mov_b32_dpp v201, v201 row_shr:1 row_mask:0xf bank_mask:0xf bound_ctrl:0
    v_mov_b32_dpp v202, v202 row_shr:1 row_mask:0xf bank_mask:0xf bound_ctrl:0
    v_mov_b32_dpp v203, v203 row_shr:1 row_mask:0xf bank_mask:0xf bound_ctrl:0
    s_waitcnt lgkmcnt(0)
    ds_read2_b32 v[64:65], v54 offset0:176 offset1:177
    ds_read2_b32 v[66:67], v54 offset0:178 offset1:179
    ds_read2_b32 v[68:69], v54 offset0:160 offset1:161
    ds_read2_b32 v[70:71], v54 offset0:162 offset1:163
    ds_read2_b32 v[72:73], v54 offset0:144 offset1:145
    ds_read2_b32 v[74:75], v54 offset0:146 offset1:147
    ds_read2_b32 v[76:77], v54 offset0:128 offset1:129
    ds_read2_b32 v[78:79], v54 offset0:130 offset1:131
    v_mfma_f32_16x16x32_bf16 v[112:115], v[84:87], v[212:215], v[112:115]
    v_mfma_f32_16x16x32_bf16 v[116:119], v[88:91], v[212:215], v[116:119]
    v_mfma_f32_16x16x32_bf16 v[120:123], v[92:95], v[212:215], v[120:123]
    v_mfma_f32_16x16x32_bf16 v[124:127], v[96:99], v[212:215], v[124:127]
    v_mov_b32_dpp v212, v212 row_shr:1 row_mask:0xf bank_mask:0xf bound_ctrl:0
    v_mov_b32_dpp v213, v213 row_shr:1 row_mask:0xf bank_mask:0xf bound_ctrl:0
    v_mov_b32_dpp v214, v214 row_shr:1 row_mask:0xf bank_mask:0xf bound_ctrl:0
    v_mov_b32_dpp v215, v215 row_shr:1 row_mask:0xf bank_mask:0xf bound_ctrl:0
    v_mfma_f32_16x16x32_bf16 v[112:115], v[88:91], v[208:211], v[112:115]
    v_mfma_f32_16x16x32_bf16 v[116:119], v[92:95], v[208:211], v[116:119]
    v_mfma_f32_16x16x32_bf16 v[120:123], v[96:99], v[208:211], v[120:123]
    v_mfma_f32_16x16x32_bf16 v[124:127], v[100:103], v[208:211], v[124:127]
    v_mov_b32_dpp v208, v208 row_shr:1 row_mask:0xf bank_mask:0xf bound_ctrl:0
    v_mov_b32_dpp v209, v209 row_shr:1 row_mask:0xf bank_mask:0xf bound_ctrl:0
    v_mov_b32_dpp v210, v210 row_shr:1 row_mask:0xf bank_mask:0xf bound_ctrl:0
    v_mov_b32_dpp v211, v211 row_shr:1 row_mask:0xf bank_mask:0xf bound_ctrl:0
    v_mfma_f32_16x16x32_bf16 v[112:115], v[92:95], v[204:207], v[112:115]
    v_mfma_f32_16x16x32_bf16 v[116:119], v[96:99], v[204:207], v[116:119]
    v_mfma_f32_16x16x32_bf16 v[120:123], v[100:103], v[204:207], v[120:123]
    v_mfma_f32_16x16x32_bf16 v[124:127], v[104:107], v[204:207], v[124:127]
    v_mov_b32_dpp v204, v204 row_shr:1 row_mask:0xf bank_mask:0xf bound_ctrl:0
    v_mov_b32_dpp v205, v205 row_shr:1 row_mask:0xf bank_mask:0xf bound_ctrl:0
    v_mov_b32_dpp v206, v206 row_shr:1 row_mask:0xf bank_mask:0xf bound_ctrl:0
    v_mov_b32_dpp v207, v207 row_shr:1 row_mask:0xf bank_mask:0xf bound_ctrl:0
    v_mfma_f32_16x16x32_bf16 v[112:115], v[96:99], v[200:203], v[112:115]
    v_mfma_f32_16x16x32_bf16 v[116:119], v[100:103], v[200:203], v[116:119]
    v_mfma_f32_16x16x32_bf16 v[120:123], v[104:107], v[200:203], v[120:123]
    v_mfma_f32_16x16x32_bf16 v[124:127], v[108:111], v[200:203], v[124:127]
    v_mov_b32_dpp v200, v200 row_shr:1 row_mask:0xf bank_mask:0xf bound_ctrl:0
    v_mov_b32_dpp v201, v201 row_shr:1 row_mask:0xf bank_mask:0xf bound_ctrl:0
    v_mov_b32_dpp v202, v202 row_shr:1 row_mask:0xf bank_mask:0xf bound_ctrl:0
    v_mov_b32_dpp v203, v203 row_shr:1 row_mask:0xf bank_mask:0xf bound_ctrl:0
    s_waitcnt lgkmcnt(0)
    ds_read2_b32 v[80:81], v54 offset0:112 offset1:113
    ds_read2_b32 v[82:83], v54 offset0:114 offset1:115
    ds_read2_b32 v[84:85], v54 offset0:96 offset1:97
    ds_read2_b32 v[86:87], v54 offset0:98 offset1:99
    ds_read2_b32 v[88:89], v54 offset0:80 offset1:81
    ds_read2_b32 v[90:91], v54 offset0:82 offset1:83
    ds_read2_b32 v[92:93], v54 offset0:64 offset1:65
    ds_read2_b32 v[94:95], v54 offset0:66 offset1:67
    v_mfma_f32_16x16x32_bf16 v[112:115], v[100:103], v[212:215], v[112:115]
    v_mfma_f32_16x16x32_bf16 v[116:119], v[104:107], v[212:215], v[116:119]
    v_mfma_f32_16x16x32_bf16 v[120:123], v[108:111], v[212:215], v[120:123]
    v_mfma_f32_16x16x32_bf16 v[124:127], v[64:67], v[212:215], v[124:127]
    v_mov_b32_dpp v212, v212 row_shr:1 row_mask:0xf bank_mask:0xf bound_ctrl:0
    v_mov_b32_dpp v213, v213 row_shr:1 row_mask:0xf bank_mask:0xf bound_ctrl:0
    v_mov_b32_dpp v214, v214 row_shr:1 row_mask:0xf bank_mask:0xf bound_ctrl:0
    v_mov_b32_dpp v215, v215 row_shr:1 row_mask:0xf bank_mask:0xf bound_ctrl:0
    v_mfma_f32_16x16x32_bf16 v[112:115], v[104:107], v[208:211], v[112:115]
    v_mfma_f32_16x16x32_bf16 v[116:119], v[108:111], v[208:211], v[116:119]
    v_mfma_f32_16x16x32_bf16 v[120:123], v[64:67], v[208:211], v[120:123]
    v_mfma_f32_16x16x32_bf16 v[124:127], v[68:71], v[208:211], v[124:127]
    v_mov_b32_dpp v208, v208 row_shr:1 row_mask:0xf bank_mask:0xf bound_ctrl:0
    v_mov_b32_dpp v209, v209 row_shr:1 row_mask:0xf bank_mask:0xf bound_ctrl:0
    v_mov_b32_dpp v210, v210 row_shr:1 row_mask:0xf bank_mask:0xf bound_ctrl:0
    v_mov_b32_dpp v211, v211 row_shr:1 row_mask:0xf bank_mask:0xf bound_ctrl:0
    v_mfma_f32_16x16x32_bf16 v[112:115], v[108:111], v[204:207], v[112:115]
    v_mfma_f32_16x16x32_bf16 v[116:119], v[64:67], v[204:207], v[116:119]
    v_mfma_f32_16x16x32_bf16 v[120:123], v[68:71], v[204:207], v[120:123]
    v_mfma_f32_16x16x32_bf16 v[124:127], v[72:75], v[204:207], v[124:127]
    v_mov_b32_dpp v204, v204 row_shr:1 row_mask:0xf bank_mask:0xf bound_ctrl:0
    v_mov_b32_dpp v205, v205 row_shr:1 row_mask:0xf bank_mask:0xf bound_ctrl:0
    v_mov_b32_dpp v206, v206 row_shr:1 row_mask:0xf bank_mask:0xf bound_ctrl:0
    v_mov_b32_dpp v207, v207 row_shr:1 row_mask:0xf bank_mask:0xf bound_ctrl:0
    v_mfma_f32_16x16x32_bf16 v[112:115], v[64:67], v[200:203], v[112:115]
    v_mfma_f32_16x16x32_bf16 v[116:119], v[68:71], v[200:203], v[116:119]
    v_mfma_f32_16x16x32_bf16 v[120:123], v[72:75], v[200:203], v[120:123]
    v_mfma_f32_16x16x32_bf16 v[124:127], v[76:79], v[200:203], v[124:127]
    v_mov_b32_dpp v200, v200 row_shr:1 row_mask:0xf bank_mask:0xf bound_ctrl:0
    v_mov_b32_dpp v201, v201 row_shr:1 row_mask:0xf bank_mask:0xf bound_ctrl:0
    v_mov_b32_dpp v202, v202 row_shr:1 row_mask:0xf bank_mask:0xf bound_ctrl:0
    v_mov_b32_dpp v203, v203 row_shr:1 row_mask:0xf bank_mask:0xf bound_ctrl:0
    s_waitcnt lgkmcnt(0)
    ds_read2_b32 v[96:97], v54 offset0:48 offset1:49
    ds_read2_b32 v[98:99], v54 offset0:50 offset1:51
    ds_read2_b32 v[100:101], v54 offset0:32 offset1:33
    ds_read2_b32 v[102:103], v54 offset0:34 offset1:35
    ds_read2_b32 v[104:105], v54 offset0:16 offset1:17
    ds_read2_b32 v[106:107], v54 offset0:18 offset1:19
    ds_read2_b32 v[108:109], v54 offset0:0 offset1:1
    ds_read2_b32 v[110:111], v54 offset0:2 offset1:3
    v_mfma_f32_16x16x32_bf16 v[112:115], v[68:71], v[212:215], v[112:115]
    v_mfma_f32_16x16x32_bf16 v[116:119], v[72:75], v[212:215], v[116:119]
    v_mfma_f32_16x16x32_bf16 v[120:123], v[76:79], v[212:215], v[120:123]
    v_mfma_f32_16x16x32_bf16 v[124:127], v[80:83], v[212:215], v[124:127]
    v_mov_b32_dpp v212, v212 row_shr:1 row_mask:0xf bank_mask:0xf bound_ctrl:0
    v_mov_b32_dpp v213, v213 row_shr:1 row_mask:0xf bank_mask:0xf bound_ctrl:0
    v_mov_b32_dpp v214, v214 row_shr:1 row_mask:0xf bank_mask:0xf bound_ctrl:0
    v_mov_b32_dpp v215, v215 row_shr:1 row_mask:0xf bank_mask:0xf bound_ctrl:0
    v_mfma_f32_16x16x32_bf16 v[112:115], v[72:75], v[208:211], v[112:115]
    v_mfma_f32_16x16x32_bf16 v[116:119], v[76:79], v[208:211], v[116:119]
    v_mfma_f32_16x16x32_bf16 v[120:123], v[80:83], v[208:211], v[120:123]
    v_mfma_f32_16x16x32_bf16 v[124:127], v[84:87], v[208:211], v[124:127]
    v_mov_b32_dpp v208, v208 row_shr:1 row_mask:0xf bank_mask:0xf bound_ctrl:0
    v_mov_b32_dpp v209, v209 row_shr:1 row_mask:0xf bank_mask:0xf bound_ctrl:0
    v_mov_b32_dpp v210, v210 row_shr:1 row_mask:0xf bank_mask:0xf bound_ctrl:0
    v_mov_b32_dpp v211, v211 row_shr:1 row_mask:0xf bank_mask:0xf bound_ctrl:0
    v_mfma_f32_16x16x32_bf16 v[112:115], v[76:79], v[204:207], v[112:115]
    v_mfma_f32_16x16x32_bf16 v[116:119], v[80:83], v[204:207], v[116:119]
    v_mfma_f32_16x16x32_bf16 v[120:123], v[84:87], v[204:207], v[120:123]
    v_mfma_f32_16x16x32_bf16 v[124:127], v[88:91], v[204:207], v[124:127]
    v_mov_b32_dpp v204, v204 row_shr:1 row_mask:0xf bank_mask:0xf bound_ctrl:0
    v_mov_b32_dpp v205, v205 row_shr:1 row_mask:0xf bank_mask:0xf bound_ctrl:0
    v_mov_b32_dpp v206, v206 row_shr:1 row_mask:0xf bank_mask:0xf bound_ctrl:0
    v_mov_b32_dpp v207, v207 row_shr:1 row_mask:0xf bank_mask:0xf bound_ctrl:0
    v_mfma_f32_16x16x32_bf16 v[112:115], v[80:83], v[200:203], v[112:115]
    v_mfma_f32_16x16x32_bf16 v[116:119], v[84:87], v[200:203], v[116:119]
    v_mfma_f32_16x16x32_bf16 v[120:123], v[88:91], v[200:203], v[120:123]
    v_mfma_f32_16x16x32_bf16 v[124:127], v[92:95], v[200:203], v[124:127]
    v_mov_b32_dpp v200, v200 row_shr:1 row_mask:0xf bank_mask:0xf bound_ctrl:0
    v_mov_b32_dpp v201, v201 row_shr:1 row_mask:0xf bank_mask:0xf bound_ctrl:0
    v_mov_b32_dpp v202, v202 row_shr:1 row_mask:0xf bank_mask:0xf bound_ctrl:0
    v_mov_b32_dpp v203, v203 row_shr:1 row_mask:0xf bank_mask:0xf bound_ctrl:0
    s_waitcnt lgkmcnt(0)
    ds_read2_b32 v[64:65], v55 offset0:240 offset1:241
    ds_read2_b32 v[66:67], v55 offset0:242 offset1:243
    ds_read2_b32 v[68:69], v55 offset0:224 offset1:225
    ds_read2_b32 v[70:71], v55 offset0:226 offset1:227
    ds_read2_b32 v[72:73], v55 offset0:208 offset1:209
    ds_read2_b32 v[74:75], v55 offset0:210 offset1:211
    ds_read2_b32 v[76:77], v55 offset0:192 offset1:193
    ds_read2_b32 v[78:79], v55 offset0:194 offset1:195
    v_mfma_f32_16x16x32_bf16 v[112:115], v[84:87], v[212:215], v[112:115]
    v_mfma_f32_16x16x32_bf16 v[116:119], v[88:91], v[212:215], v[116:119]
    v_mfma_f32_16x16x32_bf16 v[120:123], v[92:95], v[212:215], v[120:123]
    v_mfma_f32_16x16x32_bf16 v[124:127], v[96:99], v[212:215], v[124:127]
    v_mov_b32_dpp v212, v212 row_shr:1 row_mask:0xf bank_mask:0xf bound_ctrl:0
    v_mov_b32_dpp v213, v213 row_shr:1 row_mask:0xf bank_mask:0xf bound_ctrl:0
    v_mov_b32_dpp v214, v214 row_shr:1 row_mask:0xf bank_mask:0xf bound_ctrl:0
    v_mov_b32_dpp v215, v215 row_shr:1 row_mask:0xf bank_mask:0xf bound_ctrl:0
    v_mfma_f32_16x16x32_bf16 v[112:115], v[88:91], v[208:211], v[112:115]
    v_mfma_f32_16x16x32_bf16 v[116:119], v[92:95], v[208:211], v[116:119]
    v_mfma_f32_16x16x32_bf16 v[120:123], v[96:99], v[208:211], v[120:123]
    v_mfma_f32_16x16x32_bf16 v[124:127], v[100:103], v[208:211], v[124:127]
    v_mov_b32_dpp v208, v208 row_shr:1 row_mask:0xf bank_mask:0xf bound_ctrl:0
    v_mov_b32_dpp v209, v209 row_shr:1 row_mask:0xf bank_mask:0xf bound_ctrl:0
    v_mov_b32_dpp v210, v210 row_shr:1 row_mask:0xf bank_mask:0xf bound_ctrl:0
    v_mov_b32_dpp v211, v211 row_shr:1 row_mask:0xf bank_mask:0xf bound_ctrl:0
    v_mfma_f32_16x16x32_bf16 v[112:115], v[92:95], v[204:207], v[112:115]
    v_mfma_f32_16x16x32_bf16 v[116:119], v[96:99], v[204:207], v[116:119]
    v_mfma_f32_16x16x32_bf16 v[120:123], v[100:103], v[204:207], v[120:123]
    v_mfma_f32_16x16x32_bf16 v[124:127], v[104:107], v[204:207], v[124:127]
    v_mov_b32_dpp v204, v204 row_shr:1 row_mask:0xf bank_mask:0xf bound_ctrl:0
    v_mov_b32_dpp v205, v205 row_shr:1 row_mask:0xf bank_mask:0xf bound_ctrl:0
    v_mov_b32_dpp v206, v206 row_shr:1 row_mask:0xf bank_mask:0xf bound_ctrl:0
    v_mov_b32_dpp v207, v207 row_shr:1 row_mask:0xf bank_mask:0xf bound_ctrl:0
    v_mfma_f32_16x16x32_bf16 v[112:115], v[96:99], v[200:203], v[112:115]
    v_mfma_f32_16x16x32_bf16 v[116:119], v[100:103], v[200:203], v[116:119]
    v_mfma_f32_16x16x32_bf16 v[120:123], v[104:107], v[200:203], v[120:123]
    v_mfma_f32_16x16x32_bf16 v[124:127], v[108:111], v[200:203], v[124:127]
    v_mov_b32_dpp v200, v200 row_shr:1 row_mask:0xf bank_mask:0xf bound_ctrl:0
    v_mov_b32_dpp v201, v201 row_shr:1 row_mask:0xf bank_mask:0xf bound_ctrl:0
    v_mov_b32_dpp v202, v202 row_shr:1 row_mask:0xf bank_mask:0xf bound_ctrl:0
    v_mov_b32_dpp v203, v203 row_shr:1 row_mask:0xf bank_mask:0xf bound_ctrl:0
    s_waitcnt lgkmcnt(0)
    ds_read2_b32 v[80:81], v55 offset0:176 offset1:177
    ds_read2_b32 v[82:83], v55 offset0:178 offset1:179
    ds_read2_b32 v[84:85], v55 offset0:160 offset1:161
    ds_read2_b32 v[86:87], v55 offset0:162 offset1:163
    ds_read2_b32 v[88:89], v55 offset0:144 offset1:145
    ds_read2_b32 v[90:91], v55 offset0:146 offset1:147
    ds_read2_b32 v[92:93], v55 offset0:128 offset1:129
    ds_read2_b32 v[94:95], v55 offset0:130 offset1:131
    v_mfma_f32_16x16x32_bf16 v[112:115], v[100:103], v[212:215], v[112:115]
    v_mfma_f32_16x16x32_bf16 v[116:119], v[104:107], v[212:215], v[116:119]
    v_mfma_f32_16x16x32_bf16 v[120:123], v[108:111], v[212:215], v[120:123]
    v_mfma_f32_16x16x32_bf16 v[124:127], v[64:67], v[212:215], v[124:127]
    v_mov_b32_dpp v212, v212 row_shr:1 row_mask:0xf bank_mask:0xf bound_ctrl:0
    v_mov_b32_dpp v213, v213 row_shr:1 row_mask:0xf bank_mask:0xf bound_ctrl:0
    v_mov_b32_dpp v214, v214 row_shr:1 row_mask:0xf bank_mask:0xf bound_ctrl:0
    v_mov_b32_dpp v215, v215 row_shr:1 row_mask:0xf bank_mask:0xf bound_ctrl:0
    v_mfma_f32_16x16x32_bf16 v[112:115], v[104:107], v[208:211], v[112:115]
    v_mfma_f32_16x16x32_bf16 v[116:119], v[108:111], v[208:211], v[116:119]
    v_mfma_f32_16x16x32_bf16 v[120:123], v[64:67], v[208:211], v[120:123]
    v_mfma_f32_16x16x32_bf16 v[124:127], v[68:71], v[208:211], v[124:127]
    v_mov_b32_dpp v208, v208 row_shr:1 row_mask:0xf bank_mask:0xf bound_ctrl:0
    v_mov_b32_dpp v209, v209 row_shr:1 row_mask:0xf bank_mask:0xf bound_ctrl:0
    v_mov_b32_dpp v210, v210 row_shr:1 row_mask:0xf bank_mask:0xf bound_ctrl:0
    v_mov_b32_dpp v211, v211 row_shr:1 row_mask:0xf bank_mask:0xf bound_ctrl:0
    v_mfma_f32_16x16x32_bf16 v[112:115], v[108:111], v[204:207], v[112:115]
    v_mfma_f32_16x16x32_bf16 v[116:119], v[64:67], v[204:207], v[116:119]
    v_mfma_f32_16x16x32_bf16 v[120:123], v[68:71], v[204:207], v[120:123]
    v_mfma_f32_16x16x32_bf16 v[124:127], v[72:75], v[204:207], v[124:127]
    v_mov_b32_dpp v204, v204 row_shr:1 row_mask:0xf bank_mask:0xf bound_ctrl:0
    v_mov_b32_dpp v205, v205 row_shr:1 row_mask:0xf bank_mask:0xf bound_ctrl:0
    v_mov_b32_dpp v206, v206 row_shr:1 row_mask:0xf bank_mask:0xf bound_ctrl:0
    v_mov_b32_dpp v207, v207 row_shr:1 row_mask:0xf bank_mask:0xf bound_ctrl:0
    v_mfma_f32_16x16x32_bf16 v[112:115], v[64:67], v[200:203], v[112:115]
    v_mfma_f32_16x16x32_bf16 v[116:119], v[68:71], v[200:203], v[116:119]
    v_mfma_f32_16x16x32_bf16 v[120:123], v[72:75], v[200:203], v[120:123]
    v_mfma_f32_16x16x32_bf16 v[124:127], v[76:79], v[200:203], v[124:127]
    v_mov_b32_dpp v200, v200 row_shr:1 row_mask:0xf bank_mask:0xf bound_ctrl:0
    v_mov_b32_dpp v201, v201 row_shr:1 row_mask:0xf bank_mask:0xf bound_ctrl:0
    v_mov_b32_dpp v202, v202 row_shr:1 row_mask:0xf bank_mask:0xf bound_ctrl:0
    v_mov_b32_dpp v203, v203 row_shr:1 row_mask:0xf bank_mask:0xf bound_ctrl:0
    s_waitcnt lgkmcnt(0)
    ds_read2_b32 v[96:97], v55 offset0:112 offset1:113
    ds_read2_b32 v[98:99], v55 offset0:114 offset1:115
    ds_read2_b32 v[100:101], v55 offset0:96 offset1:97
    ds_read2_b32 v[102:103], v55 offset0:98 offset1:99
    ds_read2_b32 v[104:105], v55 offset0:80 offset1:81
    ds_read2_b32 v[106:107], v55 offset0:82 offset1:83
    ds_read2_b32 v[108:109], v55 offset0:64 offset1:65
    ds_read2_b32 v[110:111], v55 offset0:66 offset1:67
    v_mfma_f32_16x16x32_bf16 v[112:115], v[68:71], v[212:215], v[112:115]
    v_mfma_f32_16x16x32_bf16 v[116:119], v[72:75], v[212:215], v[116:119]
    v_mfma_f32_16x16x32_bf16 v[120:123], v[76:79], v[212:215], v[120:123]
    v_mfma_f32_16x16x32_bf16 v[124:127], v[80:83], v[212:215], v[124:127]
    v_mov_b32_dpp v212, v212 row_shr:1 row_mask:0xf bank_mask:0xf bound_ctrl:0
    v_mov_b32_dpp v213, v213 row_shr:1 row_mask:0xf bank_mask:0xf bound_ctrl:0
    v_mov_b32_dpp v214, v214 row_shr:1 row_mask:0xf bank_mask:0xf bound_ctrl:0
    v_mov_b32_dpp v215, v215 row_shr:1 row_mask:0xf bank_mask:0xf bound_ctrl:0
    v_mfma_f32_16x16x32_bf16 v[112:115], v[72:75], v[208:211], v[112:115]
    v_mfma_f32_16x16x32_bf16 v[116:119], v[76:79], v[208:211], v[116:119]
    v_mfma_f32_16x16x32_bf16 v[120:123], v[80:83], v[208:211], v[120:123]
    v_mfma_f32_16x16x32_bf16 v[124:127], v[84:87], v[208:211], v[124:127]
    v_mov_b32_dpp v208, v208 row_shr:1 row_mask:0xf bank_mask:0xf bound_ctrl:0
    v_mov_b32_dpp v209, v209 row_shr:1 row_mask:0xf bank_mask:0xf bound_ctrl:0
    v_mov_b32_dpp v210, v210 row_shr:1 row_mask:0xf bank_mask:0xf bound_ctrl:0
    v_mov_b32_dpp v211, v211 row_shr:1 row_mask:0xf bank_mask:0xf bound_ctrl:0
    v_mfma_f32_16x16x32_bf16 v[112:115], v[76:79], v[204:207], v[112:115]
    v_mfma_f32_16x16x32_bf16 v[116:119], v[80:83], v[204:207], v[116:119]
    v_mfma_f32_16x16x32_bf16 v[120:123], v[84:87], v[204:207], v[120:123]
    v_mfma_f32_16x16x32_bf16 v[124:127], v[88:91], v[204:207], v[124:127]
    v_mov_b32_dpp v204, v204 row_shr:1 row_mask:0xf bank_mask:0xf bound_ctrl:0
    v_mov_b32_dpp v205, v205 row_shr:1 row_mask:0xf bank_mask:0xf bound_ctrl:0
    v_mov_b32_dpp v206, v206 row_shr:1 row_mask:0xf bank_mask:0xf bound_ctrl:0
    v_mov_b32_dpp v207, v207 row_shr:1 row_mask:0xf bank_mask:0xf bound_ctrl:0
    v_mfma_f32_16x16x32_bf16 v[112:115], v[80:83], v[200:203], v[112:115]
    v_mfma_f32_16x16x32_bf16 v[116:119], v[84:87], v[200:203], v[116:119]
    v_mfma_f32_16x16x32_bf16 v[120:123], v[88:91], v[200:203], v[120:123]
    v_mfma_f32_16x16x32_bf16 v[124:127], v[92:95], v[200:203], v[124:127]
    v_mov_b32_dpp v200, v200 row_shr:1 row_mask:0xf bank_mask:0xf bound_ctrl:0
    v_mov_b32_dpp v201, v201 row_shr:1 row_mask:0xf bank_mask:0xf bound_ctrl:0
    v_mov_b32_dpp v202, v202 row_shr:1 row_mask:0xf bank_mask:0xf bound_ctrl:0
    v_mov_b32_dpp v203, v203 row_shr:1 row_mask:0xf bank_mask:0xf bound_ctrl:0
    s_waitcnt lgkmcnt(0)
    ds_read2_b32 v[64:65], v55 offset0:48 offset1:49
    ds_read2_b32 v[66:67], v55 offset0:50 offset1:51
    ds_read2_b32 v[68:69], v55 offset0:32 offset1:33
    ds_read2_b32 v[70:71], v55 offset0:34 offset1:35
    ds_read2_b32 v[72:73], v55 offset0:16 offset1:17
    ds_read2_b32 v[74:75], v55 offset0:18 offset1:19
    ds_read2_b32 v[76:77], v55 offset0:0 offset1:1
    ds_read2_b32 v[78:79], v55 offset0:2 offset1:3
    v_mfma_f32_16x16x32_bf16 v[112:115], v[84:87], v[212:215], v[112:115]
    v_mfma_f32_16x16x32_bf16 v[116:119], v[88:91], v[212:215], v[116:119]
    v_mfma_f32_16x16x32_bf16 v[120:123], v[92:95], v[212:215], v[120:123]
    v_mfma_f32_16x16x32_bf16 v[124:127], v[96:99], v[212:215], v[124:127]
    v_mov_b32_dpp v212, v212 row_shr:1 row_mask:0xf bank_mask:0xf bound_ctrl:0
    v_mov_b32_dpp v213, v213 row_shr:1 row_mask:0xf bank_mask:0xf bound_ctrl:0
    v_mov_b32_dpp v214, v214 row_shr:1 row_mask:0xf bank_mask:0xf bound_ctrl:0
    v_mov_b32_dpp v215, v215 row_shr:1 row_mask:0xf bank_mask:0xf bound_ctrl:0
    v_mfma_f32_16x16x32_bf16 v[112:115], v[88:91], v[208:211], v[112:115]
    v_mfma_f32_16x16x32_bf16 v[116:119], v[92:95], v[208:211], v[116:119]
    v_mfma_f32_16x16x32_bf16 v[120:123], v[96:99], v[208:211], v[120:123]
    v_mfma_f32_16x16x32_bf16 v[124:127], v[100:103], v[208:211], v[124:127]
    v_mov_b32_dpp v208, v208 row_shr:1 row_mask:0xf bank_mask:0xf bound_ctrl:0
    v_mov_b32_dpp v209, v209 row_shr:1 row_mask:0xf bank_mask:0xf bound_ctrl:0
    v_mov_b32_dpp v210, v210 row_shr:1 row_mask:0xf bank_mask:0xf bound_ctrl:0
    v_mov_b32_dpp v211, v211 row_shr:1 row_mask:0xf bank_mask:0xf bound_ctrl:0
    v_mfma_f32_16x16x32_bf16 v[112:115], v[92:95], v[204:207], v[112:115]
    v_mfma_f32_16x16x32_bf16 v[116:119], v[96:99], v[204:207], v[116:119]
    v_mfma_f32_16x16x32_bf16 v[120:123], v[100:103], v[204:207], v[120:123]
    v_mfma_f32_16x16x32_bf16 v[124:127], v[104:107], v[204:207], v[124:127]
    v_mov_b32_dpp v204, v204 row_shr:1 row_mask:0xf bank_mask:0xf bound_ctrl:0
    v_mov_b32_dpp v205, v205 row_shr:1 row_mask:0xf bank_mask:0xf bound_ctrl:0
    v_mov_b32_dpp v206, v206 row_shr:1 row_mask:0xf bank_mask:0xf bound_ctrl:0
    v_mov_b32_dpp v207, v207 row_shr:1 row_mask:0xf bank_mask:0xf bound_ctrl:0
    v_mfma_f32_16x16x32_bf16 v[112:115], v[96:99], v[200:203], v[112:115]
    v_mfma_f32_16x16x32_bf16 v[116:119], v[100:103], v[200:203], v[116:119]
    v_mfma_f32_16x16x32_bf16 v[120:123], v[104:107], v[200:203], v[120:123]
    v_mfma_f32_16x16x32_bf16 v[124:127], v[108:111], v[200:203], v[124:127]
    v_mov_b32_dpp v200, v200 row_shr:1 row_mask:0xf bank_mask:0xf bound_ctrl:0
    v_mov_b32_dpp v201, v201 row_shr:1 row_mask:0xf bank_mask:0xf bound_ctrl:0
    v_mov_b32_dpp v202, v202 row_shr:1 row_mask:0xf bank_mask:0xf bound_ctrl:0
    v_mov_b32_dpp v203, v203 row_shr:1 row_mask:0xf bank_mask:0xf bound_ctrl:0
    s_waitcnt lgkmcnt(0)
    v_mfma_f32_16x16x32_bf16 v[112:115], v[100:103], v[212:215], v[112:115]
    v_mfma_f32_16x16x32_bf16 v[116:119], v[104:107], v[212:215], v[116:119]
    v_mfma_f32_16x16x32_bf16 v[120:123], v[108:111], v[212:215], v[120:123]
    v_mfma_f32_16x16x32_bf16 v[124:127], v[64:67], v[212:215], v[124:127]
    v_mfma_f32_16x16x32_bf16 v[112:115], v[104:107], v[208:211], v[112:115]
    v_mfma_f32_16x16x32_bf16 v[116:119], v[108:111], v[208:211], v[116:119]
    v_mfma_f32_16x16x32_bf16 v[120:123], v[64:67], v[208:211], v[120:123]
    v_mfma_f32_16x16x32_bf16 v[124:127], v[68:71], v[208:211], v[124:127]
    v_mfma_f32_16x16x32_bf16 v[112:115], v[108:111], v[204:207], v[112:115]
    v_mfma_f32_16x16x32_bf16 v[116:119], v[64:67], v[204:207], v[116:119]
    v_mfma_f32_16x16x32_bf16 v[120:123], v[68:71], v[204:207], v[120:123]
    v_mfma_f32_16x16x32_bf16 v[124:127], v[72:75], v[204:207], v[124:127]
    v_mfma_f32_16x16x32_bf16 v[112:115], v[64:67], v[200:203], v[112:115]
    v_mfma_f32_16x16x32_bf16 v[116:119], v[68:71], v[200:203], v[116:119]
    v_mfma_f32_16x16x32_bf16 v[120:123], v[72:75], v[200:203], v[120:123]
    v_mfma_f32_16x16x32_bf16 v[124:127], v[76:79], v[200:203], v[124:127]
    v_lshlrev_b32 v48, 8, v3
    v_lshl_add_u32 v48, v4, 3, v48
    s_lshl_b32 s28, s26, 5
    s_add_u32 s28, s28, s17
    s_add_u32 s28, s28, 4096
    v_add_u32 v48, s28, v48
    v_cvt_pk_bf16_f32 v64, v112, v113
    v_cvt_pk_bf16_f32 v65, v114, v115
    v_cvt_pk_bf16_f32 v66, v116, v117
    v_cvt_pk_bf16_f32 v67, v118, v119
    v_cvt_pk_bf16_f32 v68, v120, v121
    v_cvt_pk_bf16_f32 v69, v122, v123
    v_cvt_pk_bf16_f32 v70, v124, v125
    v_cvt_pk_bf16_f32 v71, v126, v127
    ds_write_b64 v48, v[64:65] offset:0
    ds_write_b64 v48, v[66:67] offset:64
    ds_write_b64 v48, v[68:69] offset:128
    ds_write_b64 v48, v[70:71] offset:192
    s_waitcnt lgkmcnt(0)
    v_mov_b32 v48, 150120
    s_lshl_b32 s28, s24, 2
    v_add_u32 v49, s28, v48
    s_xor_b32 s28, s28, 4
    v_add_u32 v50, s28, v48
    ds_write_b32 v49, v46
K2_SP5:
    ds_read_b32 v48, v50 offset:0
    s_waitcnt lgkmcnt(0)
    v_readfirstlane_b32 s28, v48
    s_nop 0
    s_cmp_eq_u32 s28, 0
    s_cbranch_scc1 K2_SP5
    s_lshl_b32 s28, s26, 11
    s_add_u32 s29, s28, s17
    s_add_u32 s29, s29, 4096
    v_add_u32 v48, s29, v7
    ds_read_b128 v[64:67], v48
    ds_read_b128 v[68:71], v48 offset:1024
    s_lshl_b32 s29, s27, 12
    s_add_u32 s29, s29, s28
    s_add_u32 s29, s29, 11272192
    s_waitcnt lgkmcnt(0)
    v_min_u32 v64, -2, v64
    v_min_u32 v65, -2, v65
    v_min_u32 v66, -2, v66
    v_min_u32 v67, -2, v67
    v_min_u32 v68, -2, v68
    v_min_u32 v69, -2, v69
    v_min_u32 v70, -2, v70
    v_min_u32 v71, -2, v71
    buffer_store_dwordx4 v[64:67], v7, s[20:23], s29 offen sc1
    buffer_store_dwordx4 v[68:71], v7, s[20:23], s29 offen offset:1024 sc1
    v_mov_b32 v50, 150144
    v_and_b32 v48, 31, v1
    v_lshlrev_b32 v48, 2, v48
    s_lshl_b32 s28, s3, 7
    s_add_u32 s28, s28, 13372416
    v_add_u32 v48, s28, v48
B_PPOLL:
    buffer_load_dword v49, v48, s[20:23], 0 offen sc1
    s_waitcnt vmcnt(0)
    v_cmp_eq_u32 vcc, 0, v49
    s_nop 4
    s_cbranch_vccz B_PPOLL_OK
    s_sleep 8
    s_branch B_PPOLL
B_PPOLL_OK:
B_SWAIT:
    ds_read_b32 v49, v50
    s_waitcnt lgkmcnt(0)
    v_readfirstlane_b32 s92, v49
    s_nop 0
    s_cmp_eq_u32 s92, 0
    s_cbranch_scc0 B_SWAIT_OK
    s_sleep 4
    s_branch B_SWAIT
B_SWAIT_OK:
    v_lshrrev_b32 v48, 3, v1
    v_and_b32 v49, 7, v1
    v_lshlrev_b32 v50, 12, v48
    v_lshl_add_u32 v50, v49, 4, v50
    s_lshl_b32 s28, s3, 18
    s_lshl_b32 s29, s24, 16
    s_add_u32 s28, s28, s29
    s_lshl_b32 s29, s39, 7
    s_add_u32 s28, s28, s29
    s_add_u32 s28, s28, 11272192
    s_add_u32 s29, s28, 32768
    v_mul_u32_u24 v51, 144, v48
    v_lshl_add_u32 v51, v49, 4, v51
    s_mul_i32 s30, s24, 2304
    s_add_u32 s30, s30, 139264
    v_add_u32 v51, s30, v51
B_SLOAD:
    buffer_load_dwordx4 v[64:67], v50, s[20:23], s28 offen sc1
    buffer_load_dwordx4 v[68:71], v50, s[20:23], s29 offen sc1
    s_waitcnt vmcnt(0)
    v_max3_u32 v72, v64, v65, v66
    v_max3_u32 v73, v67, v68, v69
    v_max3_u32 v72, v72, v70, v71
    v_max_u32 v72, v72, v73
    v_cmp_eq_u32 vcc, -1, v72
    s_nop 4
    s_cbranch_vccz B_SLOADED
    s_sleep 8
    s_branch B_SLOAD
B_SLOADED:
    ds_write_b128 v51, v[64:67]
    ds_write_b128 v51, v[68:71] offset:1152
    s_waitcnt lgkmcnt(0)
K2_FINAL:
    s_nop 15
    s_nop 3
    s_barrier
    v_lshrrev_b32 v2, 3, v1
    s_lshl_b32 s28, s36, 3
    v_add_u32 v2, s28, v2
    v_and_b32 v3, 7, v1
    v_and_b32 v4, 15, v2
    v_lshlrev_b32 v6, 1, v3
    v_xor_b32 v4, v4, v6
    v_lshlrev_b32 v4, 4, v4
    v_lshl_add_u32 v4, v2, 8, v4
    v_xor_b32 v7, 16, v4
    v_add_u32 v12, 65536, v4
    v_add_u32 v13, 65536, v7
    ds_read_b128 v[16:19], v4 offset:32768
    ds_read_b128 v[20:23], v7 offset:32768
    ds_read_b128 v[24:27], v4 offset:49152
    ds_read_b128 v[28:31], v7 offset:49152
    ds_read_b128 v[32:35], v12 offset:32768
    ds_read_b128 v[36:39], v13 offset:32768
    ds_read_b128 v[40:43], v12 offset:49152
    ds_read_b128 v[44:47], v13 offset:49152
    v_mul_u32_u24 v6, 1152, v3
    v_lshl_add_u32 v6, v2, 1, v6
    v_add_u32 v6, 139264, v6
    ds_read_u16 v48, v6 offset:0
    ds_read_u16 v49, v6 offset:144
    ds_read_u16 v50, v6 offset:288
    ds_read_u16 v51, v6 offset:432
    ds_read_u16 v52, v6 offset:576
    ds_read_u16 v53, v6 offset:720
    ds_read_u16 v54, v6 offset:864
    ds_read_u16 v55, v6 offset:1008
    s_waitcnt lgkmcnt(0)
    v_add_f32 v16, v16, v24
    v_add_f32 v17, v17, v25
    v_add_f32 v18, v18, v26
    v_add_f32 v19, v19, v27
    v_add_f32 v20, v20, v28
    v_add_f32 v21, v21, v29
    v_add_f32 v22, v22, v30
    v_add_f32 v23, v23, v31
    v_add_f32 v32, v32, v40
    v_add_f32 v33, v33, v41
    v_add_f32 v34, v34, v42
    v_add_f32 v35, v35, v43
    v_add_f32 v36, v36, v44
    v_add_f32 v37, v37, v45
    v_add_f32 v38, v38, v46
    v_add_f32 v39, v39, v47
    v_add_f32 v16, v16, v32
    v_add_f32 v17, v17, v33
    v_add_f32 v18, v18, v34
    v_add_f32 v19, v19, v35
    v_add_f32 v20, v20, v36
    v_add_f32 v21, v21, v37
    v_add_f32 v22, v22, v38
    v_add_f32 v23, v23, v39
    v_cvt_pk_bf16_f32 v24, v16, v17
    v_cvt_pk_bf16_f32 v25, v18, v19
    v_cvt_pk_bf16_f32 v26, v20, v21
    v_cvt_pk_bf16_f32 v27, v22, v23
    v_lshlrev_b32 v16, 16, v24
    v_and_b32 v17, 0xffff0000, v24
    v_lshlrev_b32 v18, 16, v25
    v_and_b32 v19, 0xffff0000, v25
    v_lshlrev_b32 v20, 16, v26
    v_and_b32 v21, 0xffff0000, v26
    v_lshlrev_b32 v22, 16, v27
    v_and_b32 v23, 0xffff0000, v27
    v_mul_f32 v24, 0xbfb8aa3b, v16
    v_mul_f32 v25, 0xbfb8aa3b, v17
    v_mul_f32 v26, 0xbfb8aa3b, v18
    v_mul_f32 v27, 0xbfb8aa3b, v19
    v_mul_f32 v28, 0xbfb8aa3b, v20
    v_mul_f32 v29, 0xbfb8aa3b, v21
    v_mul_f32 v30, 0xbfb8aa3b, v22
    v_mul_f32 v31, 0xbfb8aa3b, v23
    v_exp_f32 v24, v24
    v_exp_f32 v25, v25
    v_exp_f32 v26, v26
    v_exp_f32 v27, v27
    v_exp_f32 v28, v28
    v_exp_f32 v29, v29
    v_exp_f32 v30, v30
    v_exp_f32 v31, v31
    v_add_f32 v24, 1.0, v24
    v_add_f32 v25, 1.0, v25
    v_add_f32 v26, 1.0, v26
    v_add_f32 v27, 1.0, v27
    v_add_f32 v28, 1.0, v28
    v_add_f32 v29, 1.0, v29
    v_add_f32 v30, 1.0, v30
    v_add_f32 v31, 1.0, v31
    v_rcp_f32 v24, v24
    v_rcp_f32 v25, v25
    v_rcp_f32 v26, v26
    v_rcp_f32 v27, v27
    v_rcp_f32 v28, v28
    v_rcp_f32 v29, v29
    v_rcp_f32 v30, v30
    v_rcp_f32 v31, v31
    v_mul_f32 v16, v16, v24
    v_mul_f32 v17, v17, v25
    v_mul_f32 v18, v18, v26
    v_mul_f32 v19, v19, v27
    v_mul_f32 v20, v20, v28
    v_mul_f32 v21, v21, v29
    v_mul_f32 v22, v22, v30
    v_mul_f32 v23, v23, v31
    v_cvt_pk_bf16_f32 v24, v16, v17
    v_cvt_pk_bf16_f32 v25, v18, v19
    v_cvt_pk_bf16_f32 v26, v20, v21
    v_cvt_pk_bf16_f32 v27, v22, v23
    v_lshlrev_b32 v16, 16, v24
    v_and_b32 v17, 0xffff0000, v24
    v_lshlrev_b32 v32, 16, v48
    v_lshlrev_b32 v33, 16, v49
    v_lshlrev_b32 v18, 16, v25
    v_and_b32 v19, 0xffff0000, v25
    v_lshlrev_b32 v34, 16, v50
    v_lshlrev_b32 v35, 16, v51
    v_lshlrev_b32 v20, 16, v26
    v_and_b32 v21, 0xffff0000, v26
    v_lshlrev_b32 v36, 16, v52
    v_lshlrev_b32 v37, 16, v53
    v_lshlrev_b32 v22, 16, v27
    v_and_b32 v23, 0xffff0000, v27
    v_lshlrev_b32 v38, 16, v54
    v_lshlrev_b32 v39, 16, v55
    v_mul_f32 v16, v16, v32
    v_mul_f32 v17, v17, v33
    v_mul_f32 v18, v18, v34
    v_mul_f32 v19, v19, v35
    v_mul_f32 v20, v20, v36
    v_mul_f32 v21, v21, v37
    v_mul_f32 v22, v22, v38
    v_mul_f32 v23, v23, v39
    v_cvt_pk_bf16_f32 v24, v16, v17
    v_cvt_pk_bf16_f32 v25, v18, v19
    v_cvt_pk_bf16_f32 v26, v20, v21
    v_cvt_pk_bf16_f32 v27, v22, v23
    s_waitcnt vmcnt(0)
    v_lshlrev_b32 v16, 16, v24
    v_and_b32 v17, 0xffff0000, v24
    v_lshlrev_b32 v32, 16, v252
    v_and_b32 v33, 0xffff0000, v252
    v_lshlrev_b32 v18, 16, v25
    v_and_b32 v19, 0xffff0000, v25
    v_lshlrev_b32 v34, 16, v253
    v_and_b32 v35, 0xffff0000, v253
    v_lshlrev_b32 v20, 16, v26
    v_and_b32 v21, 0xffff0000, v26
    v_lshlrev_b32 v36, 16, v254
    v_and_b32 v37, 0xffff0000, v254
    v_lshlrev_b32 v22, 16, v27
    v_and_b32 v23, 0xffff0000, v27
    v_lshlrev_b32 v38, 16, v255
    v_and_b32 v39, 0xffff0000, v255
    v_add_f32 v16, v16, v32
    v_add_f32 v17, v17, v33
    v_add_f32 v18, v18, v34
    v_add_f32 v19, v19, v35
    v_add_f32 v20, v20, v36
    v_add_f32 v21, v21, v37
    v_add_f32 v22, v22, v38
    v_add_f32 v23, v23, v39
    v_cvt_pk_bf16_f32 v24, v16, v17
    v_cvt_pk_bf16_f32 v25, v18, v19
    v_cvt_pk_bf16_f32 v26, v20, v21
    v_cvt_pk_bf16_f32 v27, v22, v23
    buffer_store_dwordx4 v[24:27], v5, s[12:15], s34 offen
MK_END:
    s_endpgm
MK_CODE_END:
.section .rodata,"a"
.p2align 6
.amdhsa_kernel recurrent_scan__ssm_conv_s4__swiglu_ffn__prompt_kernel
  .amdhsa_next_free_vgpr 256
  .amdhsa_next_free_sgpr 102
  .amdhsa_accum_offset 256
  .amdhsa_group_segment_fixed_size 0
  .amdhsa_kernarg_size 128
  .amdhsa_user_sgpr_count 2
  .amdhsa_user_sgpr_kernarg_segment_ptr 1
  .amdhsa_system_sgpr_workgroup_id_x 1
.end_amdhsa_kernel
```
